```python
import torch

def _softmax(x, axis=-1):
    return torch.softmax(x, dim=axis)
def _gelu(x):
    return torch.nn.functional.gelu(x, approximate="tanh")
def _silu(x):
    return torch.nn.functional.silu(x)
def _sigmoid(x):
    return torch.sigmoid(x)
def _layernorm(x, axis=-1, eps=1e-5):
    m = x.mean(dim=axis, keepdim=True)
    v = x.var(dim=axis, keepdim=True, unbiased=False)
    return (x - m) / torch.sqrt(v + eps)
def _scatter_add(tgt, idx, src, axis=0):
    return tgt.clone().index_add_(axis, idx, src)
def _segment_sum(src, seg, n):
    out = torch.zeros((n,) + src.shape[1:], dtype=src.dtype)
    return out.index_add_(0, seg, src)
def _pad(x, pw):
    flat = tuple(v for pair in reversed(pw) for v in pair)
    return torch.nn.functional.pad(x, flat)

kernel_name = 'gated_mix__spectral_fnet__sliding_local_dilated__prompt'

def setup_inputs():

    _w = (lambda a: (lambda t: t.to(torch.bfloat16) if t.is_floating_point() else t)(torch.as_tensor(a)))
    def _A_setup():
        B, S, D = 1, 2048, 512
        ns = torch.arange(S)[:, None] * torch.arange(S)[None, :]
        nd = torch.arange(D)[:, None] * torch.arange(D)[None, :]
        Ws_re = torch.cos(-2.0 * torch.pi * ns / S).to(float)
        Ws_im = torch.sin(-2.0 * torch.pi * ns / S).to(float)
        Wd_re = torch.cos(-2.0 * torch.pi * nd / D).to(float)
        Wd_im = torch.sin(-2.0 * torch.pi * nd / D).to(float)
        return {
            "x": _w((lambda *s: torch.randn(*s, dtype=torch.bfloat16) * 0.05)(B, S, D)),
            "dft_seq_re": _w(Ws_re),
            "dft_seq_im": _w(Ws_im),
            "dft_hid_re": _w(Wd_re),
            "dft_hid_im": _w(Wd_im),
        }
    _A_in = _A_setup()

    def _B_setup():
        B, S, D = 1, 2048, 512
        return {
            "x": _w((lambda *s: torch.randn(*s, dtype=torch.bfloat16) * 0.05)(B, S, D)),
            "wqkv": _w((lambda *s: torch.randn(*s, dtype=torch.bfloat16) * 1.6)(D, 3 * D)),
            "wo": _w((lambda *s: torch.randn(*s, dtype=torch.bfloat16) * 0.2)(D, D)),
        }
    _B_in = _B_setup()

    return {
        "A_x": _A_in["x"],
        "A_dft_seq_re": _A_in["dft_seq_re"],
        "A_dft_seq_im": _A_in["dft_seq_im"],
        "A_dft_hid_re": _A_in["dft_hid_re"],
        "A_dft_hid_im": _A_in["dft_hid_im"],
        "B_x": _B_in["x"],
        "B_wqkv": _B_in["wqkv"],
        "B_wo": _B_in["wo"],
        "gate_w": _w((lambda *s: torch.randn(*s, dtype=torch.bfloat16) * 0.05)(512) * 16.0),
    }

def reference(A_x, A_dft_seq_re, A_dft_seq_im, A_dft_hid_re, A_dft_hid_im, B_x, B_wqkv, B_wo, gate_w):
    def _A_ref(x, dft_seq_re, dft_seq_im, dft_hid_re, dft_hid_im):
        a = torch.einsum("bsd,ed->bse", x, dft_hid_re)
        b = torch.einsum("bsd,ed->bse", x, dft_hid_im)
        y = torch.einsum("ts,bse->bte", dft_seq_re, a) - torch.einsum("ts,bse->bte", dft_seq_im, b)
        return y

    def _B_ref(x, wqkv, wo):
        B, S, D = x.shape
        H = 32; Dh = D // H
        W, dil = 8, 2
        qkv = (lambda x, *d: x.permute(*d))((x @ wqkv).reshape(B, S, 3, H, Dh), 2, 0, 3, 1, 4)
        q, k, v = qkv[0], qkv[1], qkv[2]
        scale = Dh ** -0.5
        pos = torch.arange(S)
        off = torch.arange(W) * dil
        idx = pos[:, None] - off[None, :]
        mask = idx >= 0
        idx_c = torch.where(mask, idx, 0).reshape(-1)
        kg = k[:, :, idx_c, :].reshape(B, H, S, W, Dh)
        vg = v[:, :, idx_c, :].reshape(B, H, S, W, Dh)
        logits = torch.einsum("bhsd,bhswd->bhsw", q, kg) * scale
        logits = torch.where(mask[None, None, :, :], logits, -1e9)
        attn = _softmax(logits, axis=-1)
        o = torch.einsum("bhsw,bhswd->bhsd", attn, vg)
        return (lambda x, *d: x.permute(*d))(o, 0, 2, 1, 3).reshape(B, S, D) @ wo

    x = A_x
    g = _sigmoid((x * gate_w).sum(-1, keepdims=True))
    a = _A_ref(x, A_dft_seq_re, A_dft_seq_im, A_dft_hid_re, A_dft_hid_im)
    b = _B_ref(x, B_wqkv, B_wo)
    return g * a + (1 - g) * b
```

```asm
; @launch grid=(256,1,1) block=(512,1,1) lds=157184
.amdgcn_target "amdgcn-amd-amdhsa--gfx950"
.text
.globl gated_mix__spectral_fnet__sliding_local_dilated__prompt_kernel
.p2align 8
.type gated_mix__spectral_fnet__sliding_local_dilated__prompt_kernel,@function
gated_mix__spectral_fnet__sliding_local_dilated__prompt_kernel:
    s_cmp_ge_u32 s2, 256
    s_cbranch_scc1 L_exita
    s_nop 0
    s_load_dwordx2 s[4:5], s[0:1], 0
    s_load_dwordx2 s[8:9], s[0:1], 48
    s_load_dwordx2 s[12:13], s[0:1], 56
    s_load_dwordx2 s[24:25], s[0:1], 64
    s_load_dwordx2 s[20:21], s[0:1], 72
    s_load_dwordx2 s[26:27], s[0:1], 80
    s_load_dwordx2 s[16:17], s[0:1], 88
    s_getpc_b64 s[28:29]
L_pc:
    v_min_u32 v1, 132, v0
    v_lshlrev_b32 v1, 7, v1
    v_lshrrev_b32_e64 v2, 6, v0
    global_load_dword v255, v1, s[28:29]
L_nopfa:
    v_and_b32 v1, 63, v0
    v_readfirstlane_b32 s3, v2
    s_mov_b32 s7, 0x20000
    s_and_b32 s30, s2, 7
    s_lshr_b32 s31, s2, 3
    s_and_b32 s32, s30, 1
    s_lshr_b32 s33, s30, 1
    s_mov_b32 s6, 0x200000
    s_mov_b32 s10, 0x180000
    s_mov_b32 s11, s7
    s_cmp_lt_u32 s31, 4
    s_cbranch_scc1 L_fft
    s_xor_b32 s3, s3, 4
    s_lshr_b32 s34, s31, 1
    s_sub_u32 s34, s34, 2
    s_and_b32 s35, s31, 1
    s_lshl_b32 s36, s33, 1
    s_add_u32 s36, s36, s35
    s_mul_i32 s37, s34, 73
    s_min_u32 s37, s37, 944
    s_cmp_lt_u32 s3, 4
    s_cbranch_scc1 L_cons
    s_cmp_ge_u32 s3, 6
    s_cbranch_scc1 L_yq
    s_and_b32 s40, s3, 1
    v_lshrrev_b32_e64 v2, 3, v1
    v_and_b32 v3, 7, v1
    s_lshl_b32 s40, s40, 2
    v_and_or_b32 v6, v2, 2, s40
    v_xor_b32 v6, v6, v3
    v_lshlrev_b32 v6, 4, v6
    v_lshrrev_b32 v4, 1, v2
    v_or_b32 v4, s40, v4
    v_xor_b32 v4, v4, v3
    s_lshl_b32 s41, s40, 1
    s_add_u32 s42, s41, s37
    s_lshl_b32 s42, s42, 1
    s_add_u32 s42, s42, s32
    s_lshl_b32 s42, s42, 10
    v_lshlrev_b32_e64 v5, 11, v2
    v_lshl_add_u32 v5, v4, 4, v5
    v_add_u32 v5, s42, v5
    v_add_u32 v7, s41, v2
    v_mul_u32_u24 v7, 3072, v7
    s_lshl_b32 s42, s36, 7
    v_add3_u32 v7, v7, v6, s42
    s_mov_b32 s39, 0
    s_add_u32 s39, s39, s34
    s_lshl_b32 s43, s40, 8
    s_mov_b32 s45, 0
    s_mov_b32 s47, 32768
    s_mov_b32 s48, 49152
    s_waitcnt lgkmcnt(0)
L_ld:
    s_and_b32 s39, s39, 7
    s_lshl_b32 s40, s39, 7
    s_mul_i32 s41, s39, 196608
    s_mov_b32 m0, s43
    s_nop 0
    buffer_load_dwordx4 v5, s[4:7], s40 offen  lds
    s_addk_i32 m0, 2048
    s_add_u32 s40, s40, s47
    buffer_load_dwordx4 v5, s[4:7], s40 offen  lds
    s_addk_i32 m0, 2048
    s_add_u32 s40, s40, s47
    buffer_load_dwordx4 v5, s[4:7], s40 offen  lds
    s_addk_i32 m0, 2048
    s_add_u32 s40, s40, s47
    buffer_load_dwordx4 v5, s[4:7], s40 offen  lds
    s_addk_i32 m0, 2048
    s_add_u32 s40, s40, s47
    buffer_load_dwordx4 v5, s[4:7], s40 offen  lds
    s_addk_i32 m0, 2048
    s_add_u32 s45, s45, 1
    buffer_load_dwordx4 v7, s[8:11], s41 offen offset:0  lds
    s_addk_i32 m0, 7168
    s_nop 0
    buffer_load_dwordx4 v7, s[8:11], s41 offen offset:1024  lds
    s_addk_i32 m0, 7168
    s_nop 0
    buffer_load_dwordx4 v7, s[8:11], s41 offen offset:2048  lds
    s_addk_i32 m0, -12288
    s_add_u32 s41, s41, s48
    buffer_load_dwordx4 v7, s[8:11], s41 offen offset:0  lds
    s_addk_i32 m0, 7168
    s_nop 0
    buffer_load_dwordx4 v7, s[8:11], s41 offen offset:1024  lds
    s_addk_i32 m0, 7168
    s_nop 0
    buffer_load_dwordx4 v7, s[8:11], s41 offen offset:2048  lds
    s_addk_i32 m0, -12288
    s_add_u32 s41, s41, s48
    s_cmp_eq_u32 s45, 1
    s_cbranch_scc1 L_ld_go
    s_waitcnt vmcnt(11)
    s_barrier
L_ld_go:
    buffer_load_dwordx4 v7, s[8:11], s41 offen offset:0  lds
    s_addk_i32 m0, 7168
    s_nop 0
    buffer_load_dwordx4 v7, s[8:11], s41 offen offset:1024  lds
    s_addk_i32 m0, 7168
    s_nop 0
    buffer_load_dwordx4 v7, s[8:11], s41 offen offset:2048  lds
    s_addk_i32 m0, -12288
    s_add_u32 s41, s41, s48
    buffer_load_dwordx4 v7, s[8:11], s41 offen offset:0  lds
    s_addk_i32 m0, 7168
    s_nop 0
    buffer_load_dwordx4 v7, s[8:11], s41 offen offset:1024  lds
    s_addk_i32 m0, 7168
    s_nop 0
    buffer_load_dwordx4 v7, s[8:11], s41 offen offset:2048  lds
    s_add_u32 s39, s39, 1
    s_add_u32 s43, s43, 34816
    s_cmp_eq_u32 s45, 4
    s_cselect_b32 s40, 139264, 0
    s_sub_u32 s43, s43, s40
    s_cmp_lt_u32 s45, 8
    s_cbranch_scc1 L_ld
    s_and_b32 s50, s31, 7
    s_mov_b32 s14, 0x80000
    s_mov_b32 s15, 0x20000
    s_mov_b32 s18, 7340032
    s_mov_b32 s19, 0x20000
    s_mov_b32 s22, 0x200000
    s_mov_b32 s23, 0x20000
    s_lshl_b32 s42, s50, 7
    v_lshl_add_u32 v9, v2, 10, v6
    v_add_u32 v9, s42, v9
    s_and_b32 s45, s3, 1
    s_lshl_b32 s44, s50, 3
    s_add_u32 s44, s44, s45
    s_lshl_b32 s44, s44, 13
    s_lshl_b32 s45, s45, 10
    s_mov_b32 m0, s45
    s_mov_b32 s46, 6
L_woa:
    s_and_b32 s44, s44, 0x7ffff
    s_sub_u32 s46, s46, 1
    buffer_load_dwordx4 v9, s[12:15], s44 offen lds
    s_addk_i32 m0, 2048
    s_add_u32 s44, s44, 16384
    s_cmp_lg_u32 s46, 0
    s_cbranch_scc1 L_woa
    s_mov_b32 s46, 26
    s_waitcnt vmcnt(6)
    s_barrier
L_wob:
    s_and_b32 s44, s44, 0x7ffff
    s_sub_u32 s46, s46, 1
    buffer_load_dwordx4 v9, s[12:15], s44 offen lds
    s_addk_i32 m0, 2048
    s_add_u32 s44, s44, 16384
    s_cmp_lg_u32 s46, 0
    s_cbranch_scc1 L_wob
    s_waitcnt vmcnt(0)
    v_mov_b32 v248, 155648
    v_mov_b32 v249, 1
    s_mov_b64 exec, 1
    ds_add_u32 v248, v249 offset:8
    s_mov_b64 exec, -1
    s_cmp_eq_u32 s3, 4
    s_cbranch_scc1 L_enda
L_gpoll:
    v_mov_b32 v248, 155648
L_lwp:
    ds_read_b32 v249, v248 offset:16
    s_waitcnt lgkmcnt(0)
    v_cmp_gt_u32 vcc, 1, v249
    s_cbranch_vccnz L_lwp
    v_mov_b32 v248, 155648
L_lwr:
    ds_read_b32 v249, v248 offset:4
    s_waitcnt lgkmcnt(0)
    v_cmp_gt_u32 vcc, 4, v249
    s_cbranch_vccnz L_lwr
    s_lshr_b32 s41, s31, 4
    s_lshl_b32 s41, s41, 4
    s_lshl_b32 s44, s30, 1
    s_add_u32 s44, s44, s41
    s_bfe_u32 s41, s31, 0x10003
    s_add_u32 s44, s44, s41
    s_lshl_b32 s44, s44, 11
    s_add_u32 s44, s44, 5242880
    v_lshlrev_b32 v243, 7, v1
    s_mov_b32 s45, 0
    s_mov_b64 exec, 16383
L_pollq:
    v_mov_b32_e64 v244, 0
    buffer_atomic_add v244, v243, s[16:19], s44 offen sc0
L_pollwq:
    s_add_u32 s45, s45, 1
    s_waitcnt vmcnt(0)
    v_cmp_gt_u32_e64 vcc, 8, v244
    s_cmp_ge_u32 s45, 100000
    s_cbranch_scc1 L_polldq
    s_and_b64 exec, exec, vcc
    s_cbranch_execnz L_pollq
L_polldq:
    s_mov_b64 exec, -1
    v_mov_b32 v248, 155648
    v_mov_b32 v249, 1
    s_mov_b64 exec, 1
    ds_add_u32 v248, v249 offset:20
    s_mov_b64 exec, -1
    s_branch L_enda
L_yq:
    s_and_b32 s50, s31, 7
    s_nop 0
    s_mov_b32 s14, 0x80000
    s_mov_b32 s15, 0x20000
    s_mov_b32 s18, 7340032
    s_mov_b32 s19, 0x20000
    s_mov_b32 s22, 0x200000
    s_mov_b32 s23, 0x20000
    v_mov_b32 v248, 155648
    v_mov_b32 v246, 0
    v_mov_b32 v247, 0
    ds_write_b64 v248, v[246:247]
    ds_write_b64 v248, v[246:247] offset:8
    ds_write_b64 v248, v[246:247] offset:16
    ds_write_b64 v248, v[246:247] offset:24
    s_sub_u32 s56, s2, 32
    s_cmp_lg_u32 s3, 7
    s_cselect_b32 s56, 16, s56
    s_cmp_ge_u32 s56, 16
    s_cbranch_scc1 L_noclr
    s_mul_i32 s57, s56, 5120
    s_add_u32 s57, s57, 5242880
    v_lshlrev_b32 v10, 4, v1
    v_mov_b32 v232, 0
    v_mov_b32 v233, 0
    v_mov_b32_e64 v234, 0
    v_mov_b32 v235, 0
    s_waitcnt lgkmcnt(0)
    buffer_store_dwordx4 v[232:235], v10, s[16:19], s57 offen offset:0 sc1
    buffer_store_dwordx4 v[232:235], v10, s[16:19], s57 offen offset:1024 sc1
    buffer_store_dwordx4 v[232:235], v10, s[16:19], s57 offen offset:2048 sc1
    buffer_store_dwordx4 v[232:235], v10, s[16:19], s57 offen offset:3072 sc1
    s_add_u32 s57, s57, 4096
    buffer_store_dwordx4 v[232:235], v10, s[16:19], s57 offen offset:0 sc1
L_noclr:
    s_mov_b32 s52, s30
    s_lshl_b32 s52, s52, 1
    s_lshr_b32 s53, s31, 4
    s_add_u32 s52, s52, s53
    s_bfe_u32 s53, s31, 65539
    s_sub_u32 s51, 32, s52
    s_cmp_eq_u32 s52, 0
    s_cselect_b32 s51, 16, s51
    s_cselect_b32 s54, 0, s53
    s_cselect_b32 s55, s53, 0
    s_cmp_eq_u32 s53, 0
    s_cselect_b32 s51, s52, s51
    s_lshl_b32 s55, s55, 4
    s_add_u32 s52, s52, s55
    s_mov_b32 s53, s54
    v_and_b32 v2, 15, v1
    v_lshrrev_b32 v3, 4, v1
    s_and_b32 s41, s3, 1
    s_lshl_b32 s40, s41, 5
    s_lshl_b32 s42, s50, 6
    s_add_u32 s40, s40, s42
    s_cmp_lg_u32 s53, 0
    s_cselect_b64 vcc, -1, 0
    v_sub_u32 v6, 15, v2
    v_cndmask_b32 v6, v2, v6, vcc
    v_add_u32 v4, s40, v2
    s_add_u32 s40, s40, 16
    v_sub_u32 v7, 512, v4
    v_and_b32 v7, 511, v7
    v_cndmask_b32 v4, v4, v7, vcc
    v_lshrrev_b32 v7, 6, v4
    v_and_b32 v4, 63, v4
    v_lshlrev_b32 v4, 2, v4
    v_lshl_add_u32 v4, v7, 13, v4
    v_lshl_add_u32 v4, v3, 11, v4
    v_add_u32 v5, s40, v2
    s_add_u32 s40, s40, 16
    v_sub_u32 v7, 512, v5
    v_and_b32 v7, 511, v7
    v_cndmask_b32 v5, v5, v7, vcc
    v_lshrrev_b32 v7, 6, v5
    v_and_b32 v5, 63, v5
    v_lshlrev_b32 v5, 2, v5
    v_lshl_add_u32 v5, v7, 13, v5
    v_lshl_add_u32 v5, v3, 11, v5
    s_lshl_b32 s46, s52, 16
    s_add_u32 s46, s46, 2359296
    s_lshl_b32 s40, s41, 11
    s_add_u32 s40, s40, 139264
    s_mul_i32 s42, s53, 12288
    s_add_u32 s40, s40, s42
    v_lshl_add_u32 v12, v1, 4, s40
    s_mul_i32 s42, s53, -8192
    s_add_u32 s42, s42, 4096
    v_add_u32 v13, s42, v12
    v_add_u32 v14, s42, v13
    v_add_u32 v15, s42, v14
    v_and_b32_e64 v240, 1, v2
    v_lshl_add_u32 v240, v240, 5, s51
    v_lshlrev_b32 v240, 7, v240
    v_lshrrev_b32 v241, 1, v2
    v_lshl_add_u32 v240, v241, 2, v240
    v_lshlrev_b32_e64 v241, 2, v2
    v_add_u32 v241, 155712, v241
    s_mov_b32 s48, 4718592
    v_lshlrev_b32_e64 v242, 31, v6
    v_or_b32 v242, 0x3f003f00, v242
    v_cvt_f32_u32_e64 v6, v6
    v_mul_f32 v6, 0x3c800000, v6
    v_cvt_f32_u32_e64 v7, v3
    v_mul_f32 v7, 0x41000000, v7
    v_mul_f32 v7, v7, v6
    v_cmp_eq_u32 vcc, 0, v3
    v_fmamk_f32 v8, v6, 0x00000000, v7
    v_fmamk_f32 v10, v6, 0x40000000, v7
    v_cos_f32 v9, v8
    v_sin_f32 v8, v8
    v_cos_f32 v11, v10
    v_sin_f32 v10, v10
    v_cvt_pk_bf16_f32 v16, v9, v8
    v_cvt_pk_bf16_f32 v17, v11, v10
    v_fmamk_f32 v8, v6, 0x40800000, v7
    v_fmamk_f32 v10, v6, 0x40c00000, v7
    v_cos_f32 v9, v8
    v_sin_f32 v8, v8
    v_cos_f32 v11, v10
    v_sin_f32 v10, v10
    v_cvt_pk_bf16_f32 v18, v9, v8
    v_cvt_pk_bf16_f32 v19, v11, v10
    v_fmamk_f32 v8, v6, 0x3f800000, v7
    v_fmamk_f32 v10, v6, 0x40400000, v7
    v_cos_f32 v9, v8
    v_sin_f32 v8, v8
    v_cos_f32 v11, v10
    v_sin_f32 v10, v10
    v_cvt_pk_bf16_f32 v20, v9, v8
    v_cvt_pk_bf16_f32 v21, v11, v10
    v_fmamk_f32 v8, v6, 0x40a00000, v7
    v_fmamk_f32 v10, v6, 0x40e00000, v7
    v_cos_f32 v9, v8
    v_sin_f32 v8, v8
    v_cos_f32 v11, v10
    v_sin_f32 v10, v10
    v_cvt_pk_bf16_f32 v22, v9, v8
    v_cvt_pk_bf16_f32 v23, v11, v10
    v_cndmask_b32 v16, v16, v242, vcc
    v_mov_b32 v32, v16
    v_alignbit_b32 v8, v20, v20, 16
    v_xor_b32 v40, 0x00008000, v8
    v_xor_b32 v33, 0x80008000, v17
    v_alignbit_b32 v8, v21, v21, 16
    v_xor_b32 v41, 0x80000000, v8
    v_mov_b32_e64 v34, v18
    v_alignbit_b32 v8, v22, v22, 16
    v_xor_b32 v42, 0x00008000, v8
    v_xor_b32 v35, 0x80008000, v19
    v_alignbit_b32 v8, v23, v23, 16
    v_xor_b32 v43, 0x80000000, v8
    s_waitcnt lgkmcnt(0)
    s_barrier
    s_cmp_ge_u32 s56, 16
    s_cbranch_scc1 L_noclr2
    v_mov_b32 v10, 0
    v_mov_b32 v11, 1
    s_mov_b64 exec, 1
    s_waitcnt vmcnt(0)
    global_atomic_add v10, v11, s[26:27]
    s_mov_b64 exec, -1
L_noclr2:
    s_barrier
    s_barrier
    s_barrier
    s_barrier
    s_barrier
    s_barrier
    s_barrier
    s_branch L_ypoll
L_fft:
    s_lshl_b32 s35, s33, 2
    s_add_u32 s35, s31, s35
    s_lshl_b32 s35, s35, 1
    s_add_u32 s35, s35, s32
    s_lshl_b32 s36, s3, 1
    v_xor_b32 v4, s36, v1
    v_lshlrev_b32 v4, 4, v4
    s_and_b32 s34, s3, 3
    s_lshr_b32 s38, s3, 2
    s_lshl_b32 s39, s38, 3
    s_add_u32 s37, s34, s39
    s_lshl_b32 s39, s37, 6
    s_add_u32 s39, s39, s35
    s_lshl_b32 s39, s39, 10
    v_add_u32 v5, s39, v4
    s_lshl_b32 s39, s37, 10
    s_lshl_b32 s36, s35, 1
    s_sub_u32 s36, 64, s36
    s_cmp_eq_u32 s35, 0
    s_cselect_b32 s36, 32, s36
    s_mul_i32 s40, s36, s38
    s_add_u32 s40, s40, s35
    s_add_u32 s37, s36, s35
    s_lshl_b32 s36, s36, 10
    v_and_b32 v2, 15, v1
    v_lshrrev_b32 v3, 4, v1
    s_lshl_b32 s41, s3, 10
    v_lshl_add_u32 v6, v1, 4, s41
    s_add_u32 m0, s41, 139264
    s_add_u32 s28, s28, L_table-L_pc
    s_addc_u32 s29, s29, 0
    global_load_lds_dwordx4 v6, s[28:29]
    s_cmp_ge_u32 s3, 4
    s_cbranch_scc1 L_notab2
    s_addk_i32 m0, 8192
    v_add_u32 v6, 8192, v6
    global_load_lds_dwordx4 v6, s[28:29]
L_notab2:
    s_waitcnt lgkmcnt(0)
    s_cmp_lg_u32 s3, 0
    s_cbranch_scc1 L_nogw
    s_mov_b32 m0, 156160
    s_nop 0
    global_load_lds_dwordx4 v4, s[24:25]
L_nogw:
    s_add_u32 m0, s39, 0
    s_mov_b32 s46, 0
    buffer_load_dwordx4 v5, s[4:7], s46 offen lds
    s_add_u32 m0, s39, 4096
    s_mov_b32 s46, 262144
    buffer_load_dwordx4 v5, s[4:7], s46 offen lds
    s_add_u32 m0, s39, 16384
    s_mov_b32 s46, 1048576
    buffer_load_dwordx4 v5, s[4:7], s46 offen lds
    s_add_u32 m0, s39, 20480
    s_mov_b32 s46, 1310720
    buffer_load_dwordx4 v5, s[4:7], s46 offen lds
    v_lshl_add_u32 v6, v3, 9, s40
    v_cvt_f32_u32 v6, v6
    v_lshrrev_b32 v7, 3, v2
    v_cvt_f32_u32_e64 v7, v7
    v_mul_f32 v7, 0x3e800000, v7
    v_cmp_eq_u32_e64 vcc, 8, v2
    v_and_or_b32 v8, v2, 7, 0
    v_cvt_f32_u32_e64 v8, v8
    v_mul_f32 v8, 0x3d000000, v8
    v_mul_f32 v9, 0x3c800000, v8
    v_fma_f32 v9, v9, v6, v7
    v_cndmask_b32 v8, v8, 0.5, vcc
    v_cndmask_b32 v9, v9, 0, vcc
    v_fmamk_f32 v10, v8, 0x00000000, v9
    v_fmamk_f32 v11, v8, 0x3f800000, v9
    v_cos_f32_e64 v10, v10
    v_cos_f32 v11, v11
    s_nop 0
    v_cvt_pk_bf16_f32 v16, v10, v11
    v_fmamk_f32 v10, v8, 0x40000000, v9
    v_fmamk_f32 v11, v8, 0x40400000, v9
    v_cos_f32_e64 v10, v10
    v_cos_f32 v11, v11
    s_nop 0
    v_cvt_pk_bf16_f32 v17, v10, v11
    v_fmamk_f32 v10, v8, 0x40800000, v9
    v_fmamk_f32 v11, v8, 0x40a00000, v9
    v_cos_f32_e64 v10, v10
    v_cos_f32 v11, v11
    s_nop 0
    v_cvt_pk_bf16_f32 v18, v10, v11
    v_fmamk_f32 v10, v8, 0x40c00000, v9
    v_fmamk_f32 v11, v8, 0x40e00000, v9
    v_cos_f32 v10, v10
    v_cos_f32 v11, v11
    s_add_u32 m0, s39, 32768
    s_add_u32 s46, s36, 0
    buffer_load_dwordx4 v5, s[4:7], s46 offen lds
    v_cvt_pk_bf16_f32 v19, v10, v11
    v_and_or_b32 v8, v2, 7, 8
    v_cvt_f32_u32 v8, v8
    v_mul_f32 v8, 0x3d000000, v8
    v_mul_f32 v9, 0x3c800000, v8
    v_fma_f32 v9, v9, v6, v7
    v_fmamk_f32 v10, v8, 0x00000000, v9
    v_fmamk_f32 v11, v8, 0x3f800000, v9
    v_cos_f32_e64 v10, v10
    v_cos_f32 v11, v11
    s_nop 0
    v_cvt_pk_bf16_f32 v20, v10, v11
    v_fmamk_f32 v10, v8, 0x40000000, v9
    v_fmamk_f32 v11, v8, 0x40400000, v9
    v_cos_f32_e64 v10, v10
    v_cos_f32 v11, v11
    s_nop 0
    v_cvt_pk_bf16_f32 v21, v10, v11
    v_fmamk_f32 v10, v8, 0x40800000, v9
    v_fmamk_f32 v11, v8, 0x40a00000, v9
    v_cos_f32_e64 v10, v10
    v_cos_f32 v11, v11
    s_nop 0
    v_cvt_pk_bf16_f32 v22, v10, v11
    v_fmamk_f32 v10, v8, 0x40c00000, v9
    v_fmamk_f32 v11, v8, 0x40e00000, v9
    v_cos_f32_e64 v10, v10
    v_cos_f32 v11, v11
    s_nop 0
    v_cvt_pk_bf16_f32 v23, v10, v11
    s_bfe_u32 s41, s3, 0x10001
    s_and_b32 s42, s3, 1
    v_lshrrev_b32 v6, 2, v2
    v_and_b32_e64 v7, 1, v3
    v_lshl_or_b32 v7, v7, 2, v6
    v_lshl_add_u32 v6, v3, 3, v6
    s_add_u32 m0, s39, 36864
    s_add_u32 s46, s36, 262144
    buffer_load_dwordx4 v5, s[4:7], s46 offen lds
    v_lshlrev_b32 v6, 10, v6
    v_and_b32 v8, 3, v2
    v_lshl_add_u32 v6, v8, 3, v6
    s_lshl_b32 s43, s38, 15
    s_lshl_b32 s45, s42, 9
    s_add_u32 s45, s43, s45
    v_add_u32 v6, s45, v6
    v_xor_b32 v7, s41, v7
    v_xor_b32 v8, 0, v7
    v_lshl_add_u32 v72, v8, 5, v6
    v_xor_b32_e64 v8, 2, v7
    v_lshl_add_u32 v73, v8, 5, v6
    v_xor_b32_e64 v8, 4, v7
    v_lshl_add_u32 v74, v8, 5, v6
    v_xor_b32_e64 v8, 6, v7
    v_lshl_add_u32 v75, v8, 5, v6
    v_lshrrev_b32 v6, 1, v2
    v_and_b32 v6, 3, v6
    v_and_b32 v7, 2, v3
    v_or_b32 v7, s42, v7
    v_xor_b32 v7, v7, v6
    v_lshlrev_b32 v7, 4, v7
    v_lshl_add_u32 v7, v2, 6, v7
    v_and_b32_e64 v8, 1, v3
    v_lshl_add_u32 v7, v8, 13, v7
    s_add_u32 s43, s43, 65536
    s_lshl_b32 s45, s41, 10
    s_add_u32 s45, s45, s43
    v_add_u32 v76, s45, v7
    s_lshl_b32 s45, s3, 11
    s_add_u32 s45, s45, 65536
    v_xor_b32_e64 v6, v6, v3
    s_add_u32 m0, s39, 49152
    s_add_u32 s46, s36, 1048576
    buffer_load_dwordx4 v5, s[4:7], s46 offen lds
    v_lshlrev_b32_e64 v6, 4, v6
    v_lshl_add_u32 v6, v2, 6, v6
    v_add_u32 v77, s45, v6
    v_sub_u32 v6, 32, v2
    v_and_b32_e64 v6, 31, v6
    v_bfe_u32 v7, v6, 1, 2
    v_xor_b32 v7, v7, v3
    v_lshlrev_b32 v7, 4, v7
    v_lshl_add_u32 v7, v6, 6, v7
    v_add_u32 v78, s45, v7
    v_sub_u32 v6, 16, v2
    v_and_b32_e64 v6, 31, v6
    v_bfe_u32 v7, v6, 1, 2
    v_xor_b32 v7, v7, v3
    v_lshlrev_b32 v7, 4, v7
    v_lshl_add_u32 v7, v6, 6, v7
    v_add_u32 v79, s45, v7
    v_lshrrev_b32 v6, 3, v2
    v_lshlrev_b32_e64 v6, 2, v6
    v_and_or_b32 v6, v2, 3, v6
    v_lshlrev_b32_e64 v6, 1, v6
    v_xor_b32 v6, v6, v3
    s_cmp_eq_u32 s3, 5
    s_cselect_b32 s54, 0, s3
    s_lshl_b32 s45, s54, 14
    v_lshl_add_u32 v7, v2, 10, s45
    v_xor_b32_e64 v9, 0, v6
    v_lshl_add_u32 v12, v9, 4, v7
    v_xor_b32_e64 v9, 4, v6
    v_lshl_add_u32 v13, v9, 4, v7
    v_xor_b32_e64 v9, 8, v6
    v_lshl_add_u32 v14, v9, 4, v7
    s_add_u32 m0, s39, 53248
    s_add_u32 s46, s36, 1310720
    buffer_load_dwordx4 v5, s[4:7], s46 offen lds
    v_xor_b32_e64 v9, 12, v6
    v_lshl_add_u32 v15, v9, 4, v7
    v_lshlrev_b32_e64 v7, 4, v3
    v_add_u32 v6, 156160, v7
    s_cmp_lt_u32 s54, 2
    s_cselect_b32 s47, s35, s37
    s_lshl_b32 s47, s47, 7
    s_and_b32 s45, s54, 1
    s_lshl_b32 s45, s45, 6
    s_add_u32 s47, s47, s45
    s_add_u32 s47, s47, 4718592
    v_lshrrev_b32 v8, 2, v2
    v_lshlrev_b32 v8, 13, v8
    v_and_b32_e64 v9, 3, v2
    v_lshl_add_u32 v8, v9, 6, v8
    v_lshl_add_u32 v8, v3, 4, v8
    s_lshl_b32 s44, s3, 16
    s_lshl_b32 s43, s35, 8
    s_add_u32 s44, s44, s43
    s_add_u32 s44, s44, 2359296
    v_lshlrev_b32 v9, 4, v1
    v_add_u32 v9, 139264, v9
    s_and_b32 s50, s31, 7
    s_nop 0
    s_mov_b32 s14, 0x80000
    s_mov_b32 s15, 0x20000
    s_mov_b32 s18, 7340032
    s_mov_b32 s19, 0x20000
    s_mov_b32 s22, 0x200000
    s_mov_b32 s23, 0x20000
    v_mov_b32 v248, 155648
    v_mov_b32 v246, 0
    v_mov_b32 v247, 0
    ds_write_b64 v248, v[246:247]
    ds_write_b64 v248, v[246:247] offset:8
    ds_write_b64 v248, v[246:247] offset:16
    ds_write_b64 v248, v[246:247] offset:24
    s_and_b32 s41, s3, 1
    s_lshl_b32 s41, s41, 2
    v_lshrrev_b32_e64 v10, 3, v1
    v_and_or_b32 v11, v10, 2, s41
    v_and_b32 v4, 7, v1
    v_xor_b32 v11, v11, v4
    v_lshlrev_b32 v11, 4, v11
    s_lshl_b32 s41, s50, 7
    v_lshl_add_u32 v11, v10, 10, v11
    v_add_u32 v11, s41, v11
    s_and_b32 s49, s3, 3
    s_lshl_b32 s48, s50, 3
    s_add_u32 s48, s48, s49
    s_lshl_b32 s48, s48, 13
    s_lshl_b32 s49, s49, 10
    s_waitcnt vmcnt(4) lgkmcnt(0)
    s_barrier
    s_cmp_lt_u32 s3, 4
    s_cbranch_scc1 L_fgo
    ds_read_b128 v[48:51], v9 offset:0
    ds_read_b128 v[56:59], v9 offset:1024
    ds_read_b128 v[24:27], v9 offset:2048
    ds_read_b128 v[28:31], v9 offset:3072
    ds_read_b128 v[192:195], v9 offset:4096
    ds_read_b128 v[196:199], v9 offset:5120
    ds_read_b128 v[200:203], v9 offset:6144
    ds_read_b128 v[204:207], v9 offset:7168
    s_waitcnt lgkmcnt(6)
    s_nop 0
    ds_read_b128 v[32:35], v9 offset:8192
    ds_read_b128 v[36:39], v9 offset:9216
    ds_read_b128 v[40:43], v9 offset:10240
    ds_read_b128 v[44:47], v9 offset:11264
    v_xor_b32 v52, 0x80000000, v48
    v_xor_b32 v60, 0x80000000, v56
    v_xor_b32 v64, 0x80008000, v56
    v_xor_b32 v68, 0x00008000, v56
    v_xor_b32 v53, 0x80000000, v49
    v_xor_b32 v61, 0x80000000, v57
    v_xor_b32 v65, 0x80008000, v57
    v_xor_b32 v69, 0x00008000, v57
    v_xor_b32 v54, 0x80000000, v50
    v_xor_b32 v62, 0x80000000, v58
    v_xor_b32 v66, 0x80008000, v58
    v_xor_b32 v70, 0x00008000, v58
    v_xor_b32 v55, 0x80000000, v51
    v_xor_b32 v63, 0x80000000, v59
    v_xor_b32 v67, 0x80008000, v59
    v_xor_b32 v71, 0x00008000, v59
    s_waitcnt vmcnt(0) lgkmcnt(0)
    s_barrier
L_fgo:
    ds_read_b64_tr_b16 v[80:81], v72 offset:0
    ds_read_b64_tr_b16 v[82:83], v72 offset:4096
    ds_read_b64_tr_b16 v[84:85], v73 offset:0
    ds_read_b64_tr_b16 v[86:87], v73 offset:4096
    ds_read_b64_tr_b16 v[88:89], v74 offset:0
    ds_read_b64_tr_b16 v[90:91], v74 offset:4096
    ds_read_b64_tr_b16 v[92:93], v75 offset:0
    ds_read_b64_tr_b16 v[94:95], v75 offset:4096
    ds_read_b64_tr_b16 v[96:97], v72 offset:256
    ds_read_b64_tr_b16 v[98:99], v72 offset:4352
    ds_read_b64_tr_b16 v[100:101], v73 offset:256
    ds_read_b64_tr_b16 v[102:103], v73 offset:4352
    s_waitcnt lgkmcnt(10)
    v_mfma_f32_16x16x32_bf16 v[112:115], v[16:19], v[80:83], 0
    ds_read_b64_tr_b16 v[104:105], v74 offset:256
    ds_read_b64_tr_b16 v[106:107], v74 offset:4352
    s_waitcnt lgkmcnt(10)
    v_mfma_f32_16x16x32_bf16 v[116:119], v[16:19], v[84:87], 0
    ds_read_b64_tr_b16 v[108:109], v75 offset:256
    ds_read_b64_tr_b16 v[110:111], v75 offset:4352
    s_waitcnt lgkmcnt(10)
    v_mfma_f32_16x16x32_bf16 v[120:123], v[16:19], v[88:91], 0
    s_waitcnt lgkmcnt(8)
    v_mfma_f32_16x16x32_bf16 v[124:127], v[16:19], v[92:95], 0
    s_waitcnt lgkmcnt(6)
    v_mfma_f32_16x16x32_bf16 v[128:131], v[16:19], v[96:99], 0
    s_waitcnt lgkmcnt(4)
    v_mfma_f32_16x16x32_bf16 v[132:135], v[16:19], v[100:103], 0
    s_waitcnt lgkmcnt(2)
    v_mfma_f32_16x16x32_bf16 v[136:139], v[16:19], v[104:107], 0
    s_waitcnt lgkmcnt(0)
    v_mfma_f32_16x16x32_bf16 v[140:143], v[16:19], v[108:111], 0
    v_mfma_f32_16x16x32_bf16 v[144:147], v[20:23], v[80:83], 0
    v_mfma_f32_16x16x32_bf16 v[148:151], v[20:23], v[84:87], 0
    v_mfma_f32_16x16x32_bf16 v[152:155], v[20:23], v[88:91], 0
    v_mfma_f32_16x16x32_bf16 v[156:159], v[20:23], v[92:95], 0
    v_cvt_pk_bf16_f32 v176, v112, v116
    v_cvt_pk_bf16_f32 v177, v120, v124
    v_cvt_pk_bf16_f32 v178, v128, v132
    s_nop 0
    s_nop 0
    v_cvt_pk_bf16_f32 v179, v136, v140
    v_mfma_f32_16x16x32_bf16 v[160:163], v[20:23], v[96:99], 0
    ds_write_b128 v76, v[176:179] offset:0
    v_cvt_pk_bf16_f32 v180, v113, v117
    v_cvt_pk_bf16_f32 v181, v121, v125
    v_cvt_pk_bf16_f32 v182, v129, v133
    v_mfma_f32_16x16x32_bf16 v[164:167], v[20:23], v[100:103], 0
    v_cvt_pk_bf16_f32 v183, v137, v141
    ds_write_b128 v76, v[180:183] offset:2048
    v_cvt_pk_bf16_f32 v184, v114, v118
    v_cvt_pk_bf16_f32 v185, v122, v126
    v_mfma_f32_16x16x32_bf16 v[168:171], v[20:23], v[104:107], 0
    v_cvt_pk_bf16_f32 v186, v130, v134
    v_cvt_pk_bf16_f32 v187, v138, v142
    ds_write_b128 v76, v[184:187] offset:4096
    v_cvt_pk_bf16_f32 v188, v115, v119
    v_mfma_f32_16x16x32_bf16 v[172:175], v[20:23], v[108:111], 0
    v_cvt_pk_bf16_f32 v189, v123, v127
    v_cvt_pk_bf16_f32 v190, v131, v135
    v_cvt_pk_bf16_f32 v191, v139, v143
    ds_write_b128 v76, v[188:191] offset:6144
    v_cvt_pk_bf16_f32 v176, v144, v148
    v_cvt_pk_bf16_f32 v177, v152, v156
    v_cvt_pk_bf16_f32 v178, v160, v164
    s_nop 0
    s_nop 0
    v_cvt_pk_bf16_f32 v179, v168, v172
    ds_write_b128 v76, v[176:179] offset:16384
    v_cvt_pk_bf16_f32 v180, v145, v149
    v_cvt_pk_bf16_f32 v181, v153, v157
    v_cvt_pk_bf16_f32 v182, v161, v165
    v_cvt_pk_bf16_f32 v183, v169, v173
    ds_write_b128 v76, v[180:183] offset:18432
    v_cvt_pk_bf16_f32 v184, v146, v150
    v_cvt_pk_bf16_f32 v185, v154, v158
    v_cvt_pk_bf16_f32 v186, v162, v166
    v_cvt_pk_bf16_f32 v187, v170, v174
    ds_write_b128 v76, v[184:187] offset:20480
    v_cvt_pk_bf16_f32 v188, v147, v151
    v_cvt_pk_bf16_f32 v189, v155, v159
    v_cvt_pk_bf16_f32 v190, v163, v167
    v_cvt_pk_bf16_f32 v191, v171, v175
    ds_write_b128 v76, v[188:191] offset:22528
    s_cmp_ge_u32 s3, 4
    s_cbranch_scc1 L_fx
    s_waitcnt vmcnt(0)
    s_barrier
    s_lshl_b32 s46, s3, 17
    s_lshl_b32 s51, s50, 7
    s_add_u32 s46, s46, s51
    v_lshlrev_b32 v10, 10, v1
    buffer_load_dword v255, v10, s[12:15], s46 offen
    s_add_u32 s46, s46, 65536
    buffer_load_dword v255, v10, s[12:15], s46 offen
    s_cmp_lg_u32 s3, 0
    s_cbranch_scc1 L_nt2
    s_lshl_b32 s46, s2, 14
    s_add_u32 s46, s46, 512
    v_lshrrev_b32 v10, 2, v1
    v_lshlrev_b32 v10, 10, v10
    v_and_b32 v14, 3, v1
    v_lshl_add_u32 v10, v14, 7, v10
    buffer_load_dword v255, v10, s[12:15], s46 offen
L_nt2:
    ds_read_b128 v[48:51], v9 offset:0
    ds_read_b128 v[56:59], v9 offset:1024
    ds_read_b128 v[24:27], v9 offset:2048
    ds_read_b128 v[28:31], v9 offset:3072
    ds_read_b128 v[192:195], v9 offset:4096
    ds_read_b128 v[196:199], v9 offset:5120
    ds_read_b128 v[200:203], v9 offset:6144
    ds_read_b128 v[204:207], v9 offset:7168
    s_waitcnt lgkmcnt(6)
    s_nop 0
    ds_read_b128 v[32:35], v9 offset:8192
    ds_read_b128 v[36:39], v9 offset:9216
    ds_read_b128 v[40:43], v9 offset:10240
    ds_read_b128 v[44:47], v9 offset:11264
    v_xor_b32 v52, 0x80000000, v48
    v_xor_b32 v60, 0x80000000, v56
    v_xor_b32 v64, 0x80008000, v56
    v_xor_b32 v68, 0x00008000, v56
    v_xor_b32 v53, 0x80000000, v49
    v_xor_b32 v61, 0x80000000, v57
    v_xor_b32 v65, 0x80008000, v57
    v_xor_b32 v69, 0x00008000, v57
    v_xor_b32 v54, 0x80000000, v50
    v_xor_b32 v62, 0x80000000, v58
    v_xor_b32 v66, 0x80008000, v58
    v_xor_b32 v70, 0x00008000, v58
    v_xor_b32 v55, 0x80000000, v51
    v_xor_b32 v63, 0x80000000, v59
    v_xor_b32 v67, 0x80008000, v59
    v_xor_b32 v71, 0x00008000, v59
L_fx:
    v_cmp_eq_u32 s[52:53], 0, v2
    v_cmp_gt_u32 vcc, 32, v1
    s_nop 1
    v_cndmask_b32 v244, 0, -1, vcc
    s_mov_b32 s51, 0x80008000
    s_waitcnt lgkmcnt(0)
    s_barrier
    s_cmp_lg_u32 s3, 7
    s_cbranch_scc1 L_fnc0
    v_mov_b32_e64 v14, 0
    global_load_dword v15, v14, s[26:27] sc1
L_fnc0:
    ds_read_b128 v[80:83], v77 offset:0
    ds_read_b128 v[84:87], v77 offset:1024
    ds_read_b128 v[88:91], v78 offset:32768
    ds_read_b128 v[92:95], v79 offset:32768
    ds_read_b128 v[96:99], v77 offset:16384
    ds_read_b128 v[100:103], v77 offset:17408
    ds_read_b128 v[104:107], v78 offset:49152
    ds_read_b128 v[108:111], v79 offset:49152
    s_cmp_lg_u32 s35, 0
    s_cbranch_scc1 L_nosp
    v_mov_b32 v208, v192
    v_mov_b32 v216, v200
    v_mov_b32 v209, v193
    v_mov_b32 v217, v201
    v_mov_b32 v210, v194
    v_mov_b32 v218, v202
    v_mov_b32 v211, v195
    v_mov_b32 v219, v203
    v_mov_b32 v212, v196
    v_mov_b32 v220, v204
    v_mov_b32 v213, v197
    v_mov_b32 v221, v205
    v_mov_b32 v214, v198
    v_mov_b32 v222, v206
    v_mov_b32 v215, v199
    v_mov_b32 v223, v207
    v_xor_b32 v192, s51, v212
    v_mov_b32 v196, v208
    v_xor_b32 v193, s51, v213
    v_mov_b32 v197, v209
    v_xor_b32 v194, s51, v214
    v_mov_b32 v198, v210
    v_xor_b32 v195, s51, v215
    v_mov_b32 v199, v211
    v_xor_b32 v200, s51, v220
    v_mov_b32 v204, v216
    v_xor_b32 v201, s51, v221
    v_mov_b32 v205, v217
    v_xor_b32 v202, s51, v222
    v_mov_b32 v206, v218
    v_xor_b32 v203, s51, v223
    v_mov_b32 v207, v219
    v_xor_b32 v224, s51, v28
    v_mov_b32 v228, v24
    v_xor_b32 v225, s51, v29
    v_mov_b32 v229, v25
    v_xor_b32 v226, s51, v30
    v_mov_b32 v230, v26
    v_xor_b32 v227, s51, v31
    v_mov_b32 v231, v27
L_nosp:
    s_waitcnt lgkmcnt(4)
    s_cmp_lg_u32 s3, 0
    s_cbranch_scc1 L_nomask
    v_and_b32 v80, v244, v80
    v_and_b32 v81, v244, v81
    v_and_b32 v82, v244, v82
    v_and_b32 v83, v244, v83
    v_and_b32 v84, v244, v84
    v_and_b32 v85, v244, v85
    v_and_b32 v86, v244, v86
    v_and_b32 v87, v244, v87
    v_and_b32 v88, v244, v88
    v_and_b32 v89, v244, v89
    v_and_b32 v90, v244, v90
    v_and_b32 v91, v244, v91
    v_and_b32 v92, v244, v92
    v_and_b32 v93, v244, v93
    v_and_b32 v94, v244, v94
    v_and_b32 v95, v244, v95
L_nomask:
    s_cmp_eq_u32 s3, 0
    s_cselect_b64 vcc, -1, 0
    v_cndmask_b32 v245, -1, v244, vcc
    v_mfma_f32_16x16x32_bf16 v[112:115], v[80:83], v[24:27], 0
    v_cndmask_b32 v232, 0, v88, s[52:53]
    v_mfma_f32_16x16x32_bf16 v[120:123], v[80:83], v[28:31], 0
    v_cndmask_b32 v233, 0, v89, s[52:53]
    v_mfma_f32_16x16x32_bf16 v[116:119], v[84:87], v[24:27], 0
    v_cndmask_b32 v234, 0, v90, s[52:53]
    v_mfma_f32_16x16x32_bf16 v[124:127], v[84:87], v[28:31], 0
    v_cndmask_b32 v235, 0, v91, s[52:53]
    v_mfma_f32_16x16x32_bf16 v[116:119], v[92:95], v[192:195], v[116:119]
    v_mfma_f32_16x16x32_bf16 v[124:127], v[92:95], v[196:199], v[124:127]
    v_mfma_f32_16x16x32_bf16 v[112:115], v[88:91], v[192:195], v[112:115]
    v_mfma_f32_16x16x32_bf16 v[120:123], v[88:91], v[196:199], v[120:123]
    v_mfma_f32_16x16x32_bf16 v[112:115], v[232:235], v[200:203], v[112:115]
    v_mfma_f32_16x16x32_bf16 v[120:123], v[232:235], v[204:207], v[120:123]
    s_cmp_lg_u32 s35, 0
    s_cbranch_scc1 L_noex1
    ds_read_b128 v[160:163], v78 offset:0
    ds_read_b128 v[168:171], v77 offset:32768
    ds_read_b128 v[164:167], v79 offset:0
    ds_read_b128 v[172:175], v77 offset:33792
    s_waitcnt lgkmcnt(0)
    v_and_b32 v160, v245, v160
    v_and_b32 v168, v245, v168
    v_and_b32 v161, v245, v161
    v_and_b32 v169, v245, v169
    v_and_b32 v162, v245, v162
    v_and_b32 v170, v245, v170
    v_and_b32 v163, v245, v163
    v_and_b32 v171, v245, v171
    v_and_b32 v164, v245, v164
    v_and_b32 v172, v245, v172
    v_and_b32 v165, v245, v165
    v_and_b32 v173, v245, v173
    v_and_b32 v166, v245, v166
    v_and_b32 v174, v245, v174
    v_and_b32 v167, v245, v167
    v_and_b32_e64 v175, v245, v175
    v_cndmask_b32 v232, 0, v160, s[52:53]
    v_cndmask_b32 v233, 0, v161, s[52:53]
    v_cndmask_b32 v234, 0, v162, s[52:53]
    v_cndmask_b32 v235, 0, v163, s[52:53]
    v_mfma_f32_16x16x32_bf16 v[116:119], v[164:167], v[208:211], v[116:119]
    v_mfma_f32_16x16x32_bf16 v[116:119], v[172:175], v[224:227], v[116:119]
    v_mfma_f32_16x16x32_bf16 v[124:127], v[164:167], v[212:215], v[124:127]
    v_mfma_f32_16x16x32_bf16 v[124:127], v[172:175], v[228:231], v[124:127]
    v_mfma_f32_16x16x32_bf16 v[112:115], v[160:163], v[208:211], v[112:115]
    v_mfma_f32_16x16x32_bf16 v[112:115], v[168:171], v[224:227], v[112:115]
    v_mfma_f32_16x16x32_bf16 v[120:123], v[160:163], v[212:215], v[120:123]
    v_mfma_f32_16x16x32_bf16 v[120:123], v[168:171], v[228:231], v[120:123]
    v_mfma_f32_16x16x32_bf16 v[112:115], v[232:235], v[216:219], v[112:115]
    v_mfma_f32_16x16x32_bf16 v[120:123], v[232:235], v[220:223], v[120:123]
    s_nop 7
L_noex1:
    s_waitcnt lgkmcnt(0)
    v_mfma_f32_16x16x32_bf16 v[128:131], v[96:99], v[24:27], 0
    v_cndmask_b32 v232, 0, v104, s[52:53]
    v_cndmask_b32 v233, 0, v105, s[52:53]
    v_cndmask_b32 v234, 0, v106, s[52:53]
    v_cndmask_b32 v235, 0, v107, s[52:53]
    v_mul_f32_e64 v236, v124, v44
    v_mfma_f32_16x16x32_bf16 v[136:139], v[96:99], v[28:31], 0
    v_mul_f32 v238, v124, v36
    v_mul_f32 v237, v125, v45
    v_mul_f32_e64 v239, v125, v37
    v_fma_f32 v236, v116, v36, -v236
    v_fmac_f32_e64 v238, v116, v44
    v_mfma_f32_16x16x32_bf16 v[132:135], v[100:103], v[24:27], 0
    v_fma_f32 v237, v117, v37, -v237
    v_fmac_f32_e64 v239, v117, v45
    v_cvt_pk_bf16_f32 v146, v236, v237
    v_cvt_pk_bf16_f32 v150, v238, v239
    v_mul_f32_e64 v240, v126, v46
    v_mfma_f32_16x16x32_bf16 v[140:143], v[100:103], v[28:31], 0
    v_mul_f32 v242, v126, v38
    v_mul_f32 v241, v127, v47
    v_mul_f32_e64 v243, v127, v39
    v_fma_f32 v240, v118, v38, -v240
    v_fmac_f32_e64 v242, v118, v46
    v_mfma_f32_16x16x32_bf16 v[132:135], v[108:111], v[192:195], v[132:135]
    v_fma_f32 v241, v119, v39, -v241
    v_fmac_f32_e64 v243, v119, v47
    v_cvt_pk_bf16_f32 v147, v240, v241
    v_cvt_pk_bf16_f32 v151, v242, v243
    v_mul_f32_e64 v236, v120, v40
    v_mfma_f32_16x16x32_bf16 v[140:143], v[108:111], v[196:199], v[140:143]
    v_mul_f32 v238, v120, v32
    v_mul_f32 v237, v121, v41
    v_mul_f32_e64 v239, v121, v33
    v_fma_f32 v236, v112, v32, -v236
    v_fmac_f32_e64 v238, v112, v40
    v_mfma_f32_16x16x32_bf16 v[128:131], v[104:107], v[192:195], v[128:131]
    v_fma_f32 v237, v113, v33, -v237
    v_fmac_f32_e64 v239, v113, v41
    v_cvt_pk_bf16_f32 v144, v236, v237
    v_cvt_pk_bf16_f32 v148, v238, v239
    v_mul_f32_e64 v240, v122, v42
    v_mfma_f32_16x16x32_bf16 v[136:139], v[104:107], v[196:199], v[136:139]
    v_mul_f32 v242, v122, v34
    v_mul_f32 v241, v123, v43
    v_mul_f32_e64 v243, v123, v35
    v_fma_f32 v240, v114, v34, -v240
    v_fmac_f32_e64 v242, v114, v42
    v_mfma_f32_16x16x32_bf16 v[128:131], v[232:235], v[200:203], v[128:131]
    v_fma_f32 v241, v115, v35, -v241
    v_fmac_f32_e64 v243, v115, v43
    v_cvt_pk_bf16_f32 v145, v240, v241
    v_cvt_pk_bf16_f32 v149, v242, v243
    v_mfma_f32_16x16x32_bf16 v[136:139], v[232:235], v[204:207], v[136:139]
    s_cmp_lg_u32 s35, 0
    s_cbranch_scc1 L_noex2
    ds_read_b128 v[160:163], v78 offset:16384
    ds_read_b128 v[168:171], v77 offset:49152
    ds_read_b128 v[164:167], v79 offset:16384
    ds_read_b128 v[172:175], v77 offset:50176
    s_waitcnt lgkmcnt(0)
    s_nop 0
    v_cndmask_b32 v232, 0, v160, s[52:53]
    v_cndmask_b32 v233, 0, v161, s[52:53]
    v_cndmask_b32 v234, 0, v162, s[52:53]
    v_cndmask_b32 v235, 0, v163, s[52:53]
    v_mfma_f32_16x16x32_bf16 v[132:135], v[164:167], v[208:211], v[132:135]
    v_mfma_f32_16x16x32_bf16 v[132:135], v[172:175], v[224:227], v[132:135]
    v_mfma_f32_16x16x32_bf16 v[140:143], v[164:167], v[212:215], v[140:143]
    v_mfma_f32_16x16x32_bf16 v[140:143], v[172:175], v[228:231], v[140:143]
    v_mfma_f32_16x16x32_bf16 v[128:131], v[160:163], v[208:211], v[128:131]
    v_mfma_f32_16x16x32_bf16 v[128:131], v[168:171], v[224:227], v[128:131]
    v_mfma_f32_16x16x32_bf16 v[136:139], v[160:163], v[212:215], v[136:139]
    v_mfma_f32_16x16x32_bf16 v[136:139], v[168:171], v[228:231], v[136:139]
    v_mfma_f32_16x16x32_bf16 v[128:131], v[232:235], v[216:219], v[128:131]
    v_mfma_f32_16x16x32_bf16 v[136:139], v[232:235], v[220:223], v[136:139]
    s_nop 7
L_noex2:
    v_mfma_f32_16x16x32_bf16 v[160:163], v[144:147], v[48:51], 0
    v_mul_f32 v236, v140, v44
    v_mul_f32 v238, v140, v36
    v_mul_f32 v237, v141, v45
    v_mul_f32_e64 v239, v141, v37
    v_fma_f32 v236, v132, v36, -v236
    v_fmac_f32_e64 v238, v132, v44
    v_mfma_f32_16x16x32_bf16 v[164:167], v[144:147], v[64:67], 0
    v_fma_f32 v237, v133, v37, -v237
    v_fmac_f32_e64 v239, v133, v45
    v_cvt_pk_bf16_f32 v154, v236, v237
    v_cvt_pk_bf16_f32 v158, v238, v239
    v_mul_f32 v240, v142, v46
    v_mul_f32 v242, v142, v38
    v_mfma_f32_16x16x32_bf16 v[160:163], v[148:151], v[56:59], v[160:163]
    v_mul_f32 v241, v143, v47
    v_mul_f32 v243, v143, v39
    v_fma_f32 v240, v134, v38, -v240
    v_fmac_f32_e64 v242, v134, v46
    v_fma_f32 v241, v135, v39, -v241
    v_fmac_f32_e64 v243, v135, v47
    v_mfma_f32_16x16x32_bf16 v[164:167], v[148:151], v[48:51], v[164:167]
    v_cvt_pk_bf16_f32 v155, v240, v241
    v_cvt_pk_bf16_f32 v159, v242, v243
    v_mul_f32 v236, v136, v40
    v_mul_f32 v238, v136, v32
    v_mul_f32 v237, v137, v41
    v_mul_f32 v239, v137, v33
    v_mfma_f32_16x16x32_bf16 v[168:171], v[144:147], v[52:55], 0
    v_fma_f32 v236, v128, v32, -v236
    v_fmac_f32_e64 v238, v128, v40
    v_fma_f32 v237, v129, v33, -v237
    v_fmac_f32_e64 v239, v129, v41
    v_cvt_pk_bf16_f32 v152, v236, v237
    v_cvt_pk_bf16_f32 v156, v238, v239
    v_mfma_f32_16x16x32_bf16 v[172:175], v[144:147], v[68:71], 0
    v_mul_f32 v240, v138, v42
    v_mul_f32 v242, v138, v34
    v_mul_f32 v241, v139, v43
    v_mul_f32 v243, v139, v35
    v_fma_f32 v240, v130, v34, -v240
    v_fmac_f32_e64 v242, v130, v42
    v_mfma_f32_16x16x32_bf16 v[168:171], v[148:151], v[60:63], v[168:171]
    v_fma_f32 v241, v131, v35, -v241
    v_fmac_f32_e64 v243, v131, v43
    v_cvt_pk_bf16_f32 v153, v240, v241
    v_cvt_pk_bf16_f32 v157, v242, v243
    v_mfma_f32_16x16x32_bf16 v[172:175], v[148:151], v[52:55], v[172:175]
    v_mfma_f32_16x16x32_bf16 v[176:179], v[152:155], v[48:51], 0
    v_mfma_f32_16x16x32_bf16 v[180:183], v[152:155], v[64:67], 0
    v_cvt_pk_bf16_f32 v16, v160, v164
    v_cvt_pk_bf16_f32 v17, v161, v165
    v_mfma_f32_16x16x32_bf16 v[176:179], v[156:159], v[56:59], v[176:179]
    v_cvt_pk_bf16_f32 v18, v162, v166
    v_cvt_pk_bf16_f32 v19, v163, v167
    v_mfma_f32_16x16x32_bf16 v[180:183], v[156:159], v[48:51], v[180:183]
    buffer_store_dwordx4 v[16:19], v8, s[16:19], s44 offen sc1
    s_add_u32 s44, s44, 32768
    v_mfma_f32_16x16x32_bf16 v[184:187], v[152:155], v[52:55], 0
    v_cvt_pk_bf16_f32 v20, v168, v172
    v_cvt_pk_bf16_f32 v21, v169, v173
    v_mfma_f32_16x16x32_bf16 v[188:191], v[152:155], v[68:71], 0
    v_cvt_pk_bf16_f32 v22, v170, v174
    v_cvt_pk_bf16_f32 v23, v171, v175
    v_mfma_f32_16x16x32_bf16 v[184:187], v[156:159], v[60:63], v[184:187]
    buffer_store_dwordx4 v[20:23], v8, s[16:19], s44 offen sc1
    s_add_u32 s44, s44, 491520
    v_mfma_f32_16x16x32_bf16 v[188:191], v[156:159], v[52:55], v[188:191]
    v_cvt_pk_bf16_f32 v80, v176, v180
    v_cvt_pk_bf16_f32 v81, v177, v181
    v_cvt_pk_bf16_f32 v82, v178, v182
    v_cvt_pk_bf16_f32 v83, v179, v183
    buffer_store_dwordx4 v[80:83], v8, s[16:19], s44 offen sc1
    s_add_u32 s44, s44, 32768
    s_nop 1
    s_nop 0
    v_cvt_pk_bf16_f32 v84, v184, v188
    v_cvt_pk_bf16_f32 v85, v185, v189
    v_cvt_pk_bf16_f32 v86, v186, v190
    v_cvt_pk_bf16_f32 v87, v187, v191
    buffer_store_dwordx4 v[84:87], v8, s[16:19], s44 offen sc1
    s_add_u32 s44, s44, 491520
    s_cmp_eq_u32 s3, 0
    s_cbranch_scc1 L_f16
    s_cmp_ge_u32 s54, 4
    s_cbranch_scc1 L_fdone
    ds_read_b128 v[112:115], v12 offset:0
    ds_read_b128 v[116:119], v6 offset:0
    ds_read_b128 v[120:123], v13 offset:0
    ds_read_b128 v[124:127], v6 offset:64
    ds_read_b128 v[128:131], v14 offset:0
    ds_read_b128 v[132:135], v6 offset:128
    ds_read_b128 v[136:139], v15 offset:0
    ds_read_b128 v[140:143], v6 offset:192
    s_waitcnt lgkmcnt(6)
    v_mfma_f32_16x16x32_bf16 v[144:147], v[112:115], v[116:119], 0
    ds_read_b128 v[112:115], v12 offset:256
    ds_read_b128 v[116:119], v6 offset:256
    s_waitcnt lgkmcnt(6)
    v_mfma_f32_16x16x32_bf16 v[144:147], v[120:123], v[124:127], v[144:147]
    ds_read_b128 v[120:123], v13 offset:256
    ds_read_b128 v[124:127], v6 offset:320
    s_waitcnt lgkmcnt(6)
    v_mfma_f32_16x16x32_bf16 v[144:147], v[128:131], v[132:135], v[144:147]
    ds_read_b128 v[128:131], v14 offset:256
    ds_read_b128 v[132:135], v6 offset:384
    s_waitcnt lgkmcnt(6)
    v_mfma_f32_16x16x32_bf16 v[144:147], v[136:139], v[140:143], v[144:147]
    ds_read_b128 v[136:139], v15 offset:256
    ds_read_b128 v[140:143], v6 offset:448
    s_waitcnt lgkmcnt(6)
    v_mfma_f32_16x16x32_bf16 v[144:147], v[112:115], v[116:119], v[144:147]
    ds_read_b128 v[112:115], v12 offset:512
    ds_read_b128 v[116:119], v6 offset:512
    s_waitcnt lgkmcnt(6)
    v_mfma_f32_16x16x32_bf16 v[144:147], v[120:123], v[124:127], v[144:147]
    ds_read_b128 v[120:123], v13 offset:512
    ds_read_b128 v[124:127], v6 offset:576
    s_waitcnt lgkmcnt(6)
    v_mfma_f32_16x16x32_bf16 v[144:147], v[128:131], v[132:135], v[144:147]
    ds_read_b128 v[128:131], v14 offset:512
    ds_read_b128 v[132:135], v6 offset:640
    s_waitcnt lgkmcnt(6)
    v_mfma_f32_16x16x32_bf16 v[144:147], v[136:139], v[140:143], v[144:147]
    ds_read_b128 v[136:139], v15 offset:512
    ds_read_b128 v[140:143], v6 offset:704
    s_waitcnt lgkmcnt(6)
    v_mfma_f32_16x16x32_bf16 v[144:147], v[112:115], v[116:119], v[144:147]
    ds_read_b128 v[112:115], v12 offset:768
    ds_read_b128 v[116:119], v6 offset:768
    s_waitcnt lgkmcnt(6)
    v_mfma_f32_16x16x32_bf16 v[144:147], v[120:123], v[124:127], v[144:147]
    ds_read_b128 v[120:123], v13 offset:768
    ds_read_b128 v[124:127], v6 offset:832
    s_waitcnt lgkmcnt(6)
    v_mfma_f32_16x16x32_bf16 v[144:147], v[128:131], v[132:135], v[144:147]
    ds_read_b128 v[128:131], v14 offset:768
    ds_read_b128 v[132:135], v6 offset:896
    s_waitcnt lgkmcnt(6)
    v_mfma_f32_16x16x32_bf16 v[144:147], v[136:139], v[140:143], v[144:147]
    ds_read_b128 v[136:139], v15 offset:768
    ds_read_b128 v[140:143], v6 offset:960
    s_waitcnt lgkmcnt(6)
    v_mfma_f32_16x16x32_bf16 v[144:147], v[112:115], v[116:119], v[144:147]
    s_waitcnt lgkmcnt(4)
    v_mfma_f32_16x16x32_bf16 v[144:147], v[120:123], v[124:127], v[144:147]
    s_waitcnt lgkmcnt(2)
    v_mfma_f32_16x16x32_bf16 v[144:147], v[128:131], v[132:135], v[144:147]
    s_waitcnt lgkmcnt(0)
    v_mfma_f32_16x16x32_bf16 v[144:147], v[136:139], v[140:143], v[144:147]
    s_nop 7
    v_mul_f32 v144, 0xbfb8aa3b, v144
    v_mul_f32 v145, 0xbfb8aa3b, v145
    v_mul_f32 v146, 0xbfb8aa3b, v146
    v_mul_f32 v147, 0xbfb8aa3b, v147
    v_exp_f32 v144, v144
    v_exp_f32 v145, v145
    v_exp_f32 v146, v146
    v_exp_f32 v147, v147
    v_add_f32 v144, 1.0, v144
    v_add_f32 v145, 1.0, v145
    v_add_f32 v146, 1.0, v146
    v_add_f32 v147, 1.0, v147
    v_rcp_f32 v144, v144
    v_rcp_f32 v145, v145
    v_rcp_f32 v146, v146
    v_rcp_f32 v147, v147
    s_mov_b64 exec, s[52:53]
    buffer_store_dwordx4 v[144:147], v7, s[16:19], s47 offen sc1
    s_mov_b64 exec, -1
    s_branch L_fdone
L_f16:
    s_cmp_eq_u32 s35, 0
    s_cselect_b32 s41, 0, 32
    s_cselect_b32 s42, -1, 0
    v_xor_b32 v245, s42, v244
    v_xor_b32 v72, 32, v77
    v_xor_b32 v73, s41, v78
    v_xor_b32 v74, s41, v79
    v_xor_b32 v78, 32, v78
    v_xor_b32_e64 v79, 32, v79
    ds_read_b128 v[80:83], v72
    ds_read_b128 v[84:87], v72 offset:1024
    ds_read_b128 v[88:91], v73 offset:32768
    ds_read_b128 v[92:95], v74 offset:32768
    v_cvt_f32_u32_e64 v6, s35
    v_mul_f32 v6, 0x3c000000, v6
    v_cos_f32_e64 v4, v6
    v_sin_f32 v10, -v6
    s_nop 0
    s_nop 0
    v_pk_mul_f32 v[236:237], v[40:41], v[10:11] op_sel_hi:[1,0]
    v_pk_mul_f32 v[238:239], v[32:33], v[10:11] op_sel_hi:[1,0]
    v_pk_fma_f32 v[32:33], v[32:33], v[4:5], v[236:237] op_sel_hi:[1,0,1] neg_lo:[0,0,1] neg_hi:[0,0,1]
    v_pk_fma_f32 v[40:41], v[40:41], v[4:5], v[238:239] op_sel_hi:[1,0,1]
    v_pk_mul_f32 v[236:237], v[42:43], v[10:11] op_sel_hi:[1,0]
    v_pk_mul_f32 v[238:239], v[34:35], v[10:11] op_sel_hi:[1,0]
    v_pk_fma_f32 v[34:35], v[34:35], v[4:5], v[236:237] op_sel_hi:[1,0,1] neg_lo:[0,0,1] neg_hi:[0,0,1]
    v_pk_fma_f32 v[42:43], v[42:43], v[4:5], v[238:239] op_sel_hi:[1,0,1]
    v_pk_mul_f32 v[236:237], v[44:45], v[10:11] op_sel_hi:[1,0]
    v_pk_mul_f32 v[238:239], v[36:37], v[10:11] op_sel_hi:[1,0]
    v_pk_fma_f32 v[36:37], v[36:37], v[4:5], v[236:237] op_sel_hi:[1,0,1] neg_lo:[0,0,1] neg_hi:[0,0,1]
    v_pk_fma_f32 v[44:45], v[44:45], v[4:5], v[238:239] op_sel_hi:[1,0,1]
    v_pk_mul_f32 v[236:237], v[46:47], v[10:11] op_sel_hi:[1,0]
    v_pk_mul_f32 v[238:239], v[38:39], v[10:11] op_sel_hi:[1,0]
    v_pk_fma_f32 v[38:39], v[38:39], v[4:5], v[236:237] op_sel_hi:[1,0,1] neg_lo:[0,0,1] neg_hi:[0,0,1]
    v_pk_fma_f32 v[46:47], v[46:47], v[4:5], v[238:239] op_sel_hi:[1,0,1]
    s_waitcnt lgkmcnt(0)
    v_and_b32 v80, v244, v80
    v_bitop3_b32 v88, v88, s51, v245 bitop3:0x28
    v_and_b32_e64 v81, v244, v81
    v_bitop3_b32 v89, v89, s51, v245 bitop3:0x28
    v_and_b32_e64 v82, v244, v82
    v_bitop3_b32 v90, v90, s51, v245 bitop3:0x28
    v_and_b32_e64 v83, v244, v83
    v_bitop3_b32 v91, v91, s51, v245 bitop3:0x28
    v_and_b32_e64 v84, v244, v84
    v_bitop3_b32 v92, v92, s51, v245 bitop3:0x28
    v_and_b32_e64 v85, v244, v85
    v_bitop3_b32 v93, v93, s51, v245 bitop3:0x28
    v_and_b32_e64 v86, v244, v86
    v_bitop3_b32 v94, v94, s51, v245 bitop3:0x28
    v_and_b32_e64 v87, v244, v87
    v_bitop3_b32 v95, v95, s51, v245 bitop3:0x28
    v_cndmask_b32 v232, 0, v88, s[52:53]
    v_cndmask_b32 v233, 0, v89, s[52:53]
    v_cndmask_b32 v234, 0, v90, s[52:53]
    v_cndmask_b32 v235, 0, v91, s[52:53]
    v_mfma_f32_16x16x32_bf16 v[112:115], v[80:83], v[24:27], 0
    v_mfma_f32_16x16x32_bf16 v[120:123], v[80:83], v[28:31], 0
    v_mfma_f32_16x16x32_bf16 v[116:119], v[84:87], v[24:27], 0
    v_mfma_f32_16x16x32_bf16 v[124:127], v[84:87], v[28:31], 0
    v_mfma_f32_16x16x32_bf16 v[116:119], v[92:95], v[192:195], v[116:119]
    v_mfma_f32_16x16x32_bf16 v[124:127], v[92:95], v[196:199], v[124:127]
    v_mfma_f32_16x16x32_bf16 v[112:115], v[88:91], v[192:195], v[112:115]
    v_mfma_f32_16x16x32_bf16 v[120:123], v[88:91], v[196:199], v[120:123]
    v_mfma_f32_16x16x32_bf16 v[112:115], v[232:235], v[200:203], v[112:115]
    v_mfma_f32_16x16x32_bf16 v[120:123], v[232:235], v[204:207], v[120:123]
    s_cmp_lg_u32 s35, 0
    s_cbranch_scc1 L_noex3
    ds_read_b128 v[160:163], v78 offset:0
    ds_read_b128 v[168:171], v77 offset:32768
    ds_read_b128 v[164:167], v79 offset:0
    ds_read_b128 v[172:175], v77 offset:33792
    s_waitcnt lgkmcnt(0)
    v_and_b32 v160, v244, v160
    v_bitop3_b32 v168, v168, s51, v245 bitop3:0x28
    v_and_b32_e64 v161, v244, v161
    v_bitop3_b32 v169, v169, s51, v245 bitop3:0x28
    v_and_b32_e64 v162, v244, v162
    v_bitop3_b32 v170, v170, s51, v245 bitop3:0x28
    v_and_b32_e64 v163, v244, v163
    v_bitop3_b32 v171, v171, s51, v245 bitop3:0x28
    v_and_b32_e64 v164, v244, v164
    v_bitop3_b32 v172, v172, s51, v245 bitop3:0x28
    v_and_b32_e64 v165, v244, v165
    v_bitop3_b32 v173, v173, s51, v245 bitop3:0x28
    v_and_b32_e64 v166, v244, v166
    v_bitop3_b32 v174, v174, s51, v245 bitop3:0x28
    v_and_b32_e64 v167, v244, v167
    v_bitop3_b32 v175, v175, s51, v245 bitop3:0x28
    v_cndmask_b32 v232, 0, v160, s[52:53]
    v_cndmask_b32 v233, 0, v161, s[52:53]
    v_cndmask_b32 v234, 0, v162, s[52:53]
    v_cndmask_b32 v235, 0, v163, s[52:53]
    v_mfma_f32_16x16x32_bf16 v[116:119], v[164:167], v[208:211], v[116:119]
    v_mfma_f32_16x16x32_bf16 v[116:119], v[172:175], v[224:227], v[116:119]
    v_mfma_f32_16x16x32_bf16 v[124:127], v[164:167], v[212:215], v[124:127]
    v_mfma_f32_16x16x32_bf16 v[124:127], v[172:175], v[228:231], v[124:127]
    v_mfma_f32_16x16x32_bf16 v[112:115], v[160:163], v[208:211], v[112:115]
    v_mfma_f32_16x16x32_bf16 v[112:115], v[168:171], v[224:227], v[112:115]
    v_mfma_f32_16x16x32_bf16 v[120:123], v[160:163], v[212:215], v[120:123]
    v_mfma_f32_16x16x32_bf16 v[120:123], v[168:171], v[228:231], v[120:123]
    v_mfma_f32_16x16x32_bf16 v[112:115], v[232:235], v[216:219], v[112:115]
    v_mfma_f32_16x16x32_bf16 v[120:123], v[232:235], v[220:223], v[120:123]
    s_nop 7
L_noex3:
    s_nop 1
    v_mul_f32 v236, v124, v44
    v_mul_f32 v238, v124, v36
    v_mul_f32 v237, v125, v45
    v_mul_f32 v239, v125, v37
    v_fma_f32 v236, v116, v36, -v236
    v_fmac_f32_e64 v238, v116, v44
    v_fma_f32 v237, v117, v37, -v237
    v_fmac_f32_e64 v239, v117, v45
    v_cvt_pk_bf16_f32 v146, v236, v237
    v_cvt_pk_bf16_f32 v150, v238, v239
    v_mul_f32 v240, v126, v46
    v_mul_f32 v242, v126, v38
    v_mul_f32 v241, v127, v47
    v_mul_f32 v243, v127, v39
    v_fma_f32 v240, v118, v38, -v240
    v_fmac_f32_e64 v242, v118, v46
    v_fma_f32 v241, v119, v39, -v241
    v_fmac_f32_e64 v243, v119, v47
    v_cvt_pk_bf16_f32 v147, v240, v241
    v_cvt_pk_bf16_f32 v151, v242, v243
    v_mul_f32 v236, v120, v40
    v_mul_f32 v238, v120, v32
    v_mul_f32 v237, v121, v41
    v_mul_f32 v239, v121, v33
    v_fma_f32 v236, v112, v32, -v236
    v_fmac_f32_e64 v238, v112, v40
    v_fma_f32 v237, v113, v33, -v237
    v_fmac_f32_e64 v239, v113, v41
    v_cvt_pk_bf16_f32 v144, v236, v237
    v_cvt_pk_bf16_f32 v148, v238, v239
    v_mul_f32 v240, v122, v42
    v_mul_f32 v242, v122, v34
    v_mul_f32 v241, v123, v43
    v_mul_f32 v243, v123, v35
    v_fma_f32 v240, v114, v34, -v240
    v_fmac_f32_e64 v242, v114, v42
    v_fma_f32 v241, v115, v35, -v241
    v_fmac_f32_e64 v243, v115, v43
    v_cvt_pk_bf16_f32 v145, v240, v241
    v_cvt_pk_bf16_f32 v149, v242, v243
    s_nop 0
    s_nop 0
    v_mfma_f32_16x16x32_bf16 v[160:163], v[144:147], v[48:51], 0
    v_mfma_f32_16x16x32_bf16 v[164:167], v[144:147], v[64:67], 0
    v_mfma_f32_16x16x32_bf16 v[160:163], v[148:151], v[56:59], v[160:163]
    v_mfma_f32_16x16x32_bf16 v[164:167], v[148:151], v[48:51], v[164:167]
    v_mfma_f32_16x16x32_bf16 v[168:171], v[144:147], v[52:55], 0
    v_mfma_f32_16x16x32_bf16 v[172:175], v[144:147], v[68:71], 0
    v_mfma_f32_16x16x32_bf16 v[168:171], v[148:151], v[60:63], v[168:171]
    v_mfma_f32_16x16x32_bf16 v[172:175], v[148:151], v[52:55], v[172:175]
    s_nop 3
    s_nop 0
    v_cvt_pk_bf16_f32 v16, v160, v164
    v_cvt_pk_bf16_f32 v17, v161, v165
    v_cvt_pk_bf16_f32 v18, v162, v166
    v_cvt_pk_bf16_f32 v19, v163, v167
    buffer_store_dwordx4 v[16:19], v8, s[16:19], s44 offen sc1
    s_add_u32 s44, s44, 32768
    v_cvt_pk_bf16_f32 v20, v168, v172
    v_cvt_pk_bf16_f32 v21, v169, v173
    v_cvt_pk_bf16_f32 v22, v170, v174
    v_cvt_pk_bf16_f32 v23, v171, v175
    buffer_store_dwordx4 v[20:23], v8, s[16:19], s44 offen sc1
    s_add_u32 s44, s44, 0
L_fdone:
    s_cmp_lg_u32 s3, 7
    s_cbranch_scc1 L_fnochk
    s_waitcnt vmcnt(4)
    v_cmp_le_u32 vcc, 16, v15
    s_cbranch_vccnz L_fnochk
    v_mov_b32 v10, 0
    s_mov_b32 s45, 0
L_chkf:
    global_load_dword v11, v10, s[26:27] sc1
    s_add_u32 s45, s45, 1
    s_cmp_gt_u32 s45, 100000
    s_cbranch_scc1 L_chkdf
    s_waitcnt vmcnt(0)
    v_cmp_gt_u32 vcc, 16, v11
    s_cbranch_vccnz L_chkf
L_chkdf:
L_fnochk:
    s_waitcnt vmcnt(0)
    s_barrier
    s_cmp_lg_u32 s3, 5
    s_cbranch_scc1 L_fnosig
    s_and_b32 s40, s31, 2
    s_add_u32 s40, s40, s32
    s_lshl_b32 s40, s40, 7
    s_add_u32 s40, s40, 5308416
    v_lshlrev_b32 v243, 9, v1
    s_mov_b32 exec_hi, 0
    v_mov_b32_e64 v244, 1
    buffer_atomic_add v244, v243, s[16:19], s40 offen
    s_mov_b64 exec, -1
L_fnosig:
    s_cmp_ge_u32 s3, 4
    s_cbranch_scc1 L_fhi
    s_mov_b32 s46, 4
L_fwo:
    s_mov_b32 m0, s49
    s_and_b32 s48, s48, 0x7ffff
    s_add_u32 s49, s49, 4096
    buffer_load_dwordx4 v11, s[12:15], s48 offen lds
    s_add_u32 s48, s48, 32768
    s_mov_b32 m0, s49
    s_and_b32 s48, s48, 0x7ffff
    s_add_u32 s49, s49, 4096
    buffer_load_dwordx4 v11, s[12:15], s48 offen lds
    s_add_u32 s48, s48, 32768
    s_mov_b32 m0, s49
    s_and_b32 s48, s48, 0x7ffff
    s_add_u32 s49, s49, 4096
    buffer_load_dwordx4 v11, s[12:15], s48 offen lds
    s_add_u32 s48, s48, 32768
    s_mov_b32 m0, s49
    s_and_b32 s48, s48, 0x7ffff
    s_add_u32 s49, s49, 4096
    buffer_load_dwordx4 v11, s[12:15], s48 offen lds
    s_add_u32 s48, s48, 32768
    s_sub_u32 s46, s46, 1
    s_cmp_lg_u32 s46, 0
    s_cbranch_scc1 L_fwo
    s_waitcnt vmcnt(0)
    v_mov_b32 v248, 155648
    v_mov_b32 v249, 1
    s_mov_b64 exec, 1
    ds_add_rtn_u32 v249, v248, v249 offset:28
    s_waitcnt lgkmcnt(0)
    v_readfirstlane_b32 s44, v249
    s_mov_b64 exec, -1
    s_mov_b32 s49, 1
    s_cmp_lg_u32 s44, 3
    s_cbranch_scc1 L_p2b
    v_mov_b32 v248, 155648
    v_mov_b32 v249, 4
    s_mov_b64 exec, 1
    ds_add_u32 v248, v249 offset:8
    s_mov_b64 exec, -1
    v_mov_b32 v248, 155648
    v_mov_b32 v249, 4
    s_mov_b64 exec, 1
    ds_add_u32 v248, v249 offset:4
    s_mov_b64 exec, -1
    s_branch L_p2b
L_fhi:
    s_cmp_ge_u32 s3, 6
    s_cbranch_scc1 L_yfft
    s_cmp_eq_u32 s3, 5
    s_cbranch_scc1 L_gpoll
    v_mov_b32 v248, 155648
    v_mov_b32 v249, 1
    s_mov_b64 exec, 1
    ds_add_u32 v248, v249 offset:16
    s_mov_b64 exec, -1
    v_mov_b32 v248, 155648
    v_mov_b32 v249, 4
    s_mov_b64 exec, 1
    ds_add_u32 v248, v249 offset:0
    s_mov_b64 exec, -1
    s_lshl_b32 s40, s30, 2
    s_lshr_b32 s41, s31, 3
    s_add_u32 s40, s40, s41
    s_lshl_b32 s40, s40, 9
    s_add_u32 s40, s40, 5308416
    v_lshlrev_b32 v243, 7, v1
    s_mov_b32 s45, 0
    s_mov_b64 exec, 15
L_polle:
    v_mov_b32_e64 v244, 0
    buffer_atomic_add v244, v243, s[16:19], s40 offen sc0
L_pollwe:
    s_add_u32 s45, s45, 1
    s_waitcnt vmcnt(0)
    v_cmp_gt_u32_e64 vcc, 8, v244
    s_cmp_ge_u32 s45, 100000
    s_cbranch_scc1 L_pollde
    s_and_b64 exec, exec, vcc
    s_cbranch_execnz L_polle
L_pollde:
    s_mov_b64 exec, -1
    v_mov_b32 v248, 155648
    v_mov_b32 v249, 1
    s_mov_b64 exec, 1
    ds_add_u32 v248, v249 offset:12
    s_mov_b64 exec, -1
    s_branch L_enda
L_cons:
    s_and_b32 s50, s31, 7
    s_nop 0
    s_mov_b32 s14, 0x80000
    s_mov_b32 s15, 0x20000
    s_mov_b32 s18, 7340032
    s_mov_b32 s19, 0x20000
    s_mov_b32 s22, 0x200000
    s_mov_b32 s23, 0x20000
    v_and_b32 v2, 15, v1
    v_lshrrev_b32 v3, 4, v1
    v_lshrrev_b32 v4, 1, v2
    v_xor_b32 v4, v4, v3
    v_lshlrev_b32_e64 v4, 4, v4
    v_lshl_add_u32 v4, v2, 7, v4
    v_xor_b32 v5, 64, v4
    v_lshrrev_b32 v6, 3, v2
    v_and_b32_e64 v10, 1, v3
    v_lshl_or_b32 v6, v10, 1, v6
    v_xor_b32 v6, s3, v6
    v_lshlrev_b32 v6, 5, v6
    v_and_b32_e64 v10, 3, v2
    v_lshl_add_u32 v6, v10, 3, v6
    v_lshrrev_b32_e64 v10, 2, v2
    v_lshl_add_u32 v10, v3, 3, v10
    v_lshl_add_u32 v6, v10, 7, v6
    v_mov_b32 v16, 0
    v_mov_b32 v17, 0
    v_mov_b32 v18, 0
    v_mov_b32 v19, 0
    v_mov_b32 v20, 0
    v_mov_b32 v21, 0
    v_mov_b32 v22, 0
    v_mov_b32 v23, 0
    v_mov_b32 v24, 0
    v_mov_b32 v25, 0
    v_mov_b32 v26, 0
    v_mov_b32 v27, 0
    v_mov_b32 v28, 0
    v_mov_b32 v29, 0
    v_mov_b32 v30, 0
    v_mov_b32 v31, 0
    v_mov_b32 v32, 0
    v_mov_b32 v33, 0
    v_mov_b32 v34, 0
    v_mov_b32 v35, 0
    v_mov_b32 v36, 0
    v_mov_b32 v37, 0
    v_mov_b32 v38, 0
    v_mov_b32 v39, 0
    v_mov_b32 v40, 0
    v_mov_b32 v41, 0
    v_mov_b32 v42, 0
    v_mov_b32 v43, 0
    v_mov_b32 v44, 0
    v_mov_b32 v45, 0
    v_mov_b32 v46, 0
    v_mov_b32 v47, 0
    v_mov_b32 v48, 0
    v_mov_b32 v49, 0
    v_mov_b32 v50, 0
    v_mov_b32 v51, 0
    v_mov_b32 v52, 0
    v_mov_b32 v53, 0
    v_mov_b32 v54, 0
    v_mov_b32 v55, 0
    v_mov_b32 v56, 0
    v_mov_b32 v57, 0
    v_mov_b32 v58, 0
    v_mov_b32 v59, 0
    v_mov_b32 v60, 0
    v_mov_b32 v61, 0
    v_mov_b32 v62, 0
    v_mov_b32 v63, 0
    v_mov_b32 v64, 0
    v_mov_b32 v65, 0
    v_mov_b32 v66, 0
    v_mov_b32 v67, 0
    v_mov_b32 v68, 0
    v_mov_b32 v69, 0
    v_mov_b32 v70, 0
    v_mov_b32 v71, 0
    v_mov_b32 v72, 0
    v_mov_b32 v73, 0
    v_mov_b32 v74, 0
    v_mov_b32 v75, 0
    v_lshlrev_b32 v10, 2, v3
    v_sub_u32 v10, v2, v10
    v_mov_b32 v12, 0xf149f2ca
    v_subrev_u32_e64 v11, 0, v10
    v_cmp_gt_u32 s[40:41], 8, v11
    v_cmp_gt_i32 vcc, -8, v11
    s_nop 0
    v_cndmask_b32 v140, v12, 0, s[40:41]
    v_cndmask_b32 v144, v12, 0, vcc
    v_subrev_u32_e64 v11, 1, v10
    v_cmp_gt_u32 s[42:43], 8, v11
    v_cmp_gt_i32 vcc, -8, v11
    s_nop 0
    v_cndmask_b32 v141, v12, 0, s[42:43]
    v_cndmask_b32 v145, v12, 0, vcc
    v_subrev_u32_e64 v11, 2, v10
    v_cmp_gt_u32 s[44:45], 8, v11
    v_cmp_gt_i32 vcc, -8, v11
    s_nop 0
    v_cndmask_b32 v142, v12, 0, s[44:45]
    v_cndmask_b32 v146, v12, 0, vcc
    v_subrev_u32_e64 v11, 3, v10
    v_cmp_gt_u32 s[46:47], 8, v11
    v_cmp_gt_i32 vcc, -8, v11
    s_nop 0
    v_cndmask_b32 v143, v12, 0, s[46:47]
    v_cndmask_b32 v147, v12, 0, vcc
    v_mov_b32 v12, 0x0302
    v_mov_b32 v13, 0x0c0c
    v_cndmask_b32 v148, v13, v12, s[40:41]
    v_cndmask_b32 v149, v13, v12, s[44:45]
    v_mov_b32 v12, 0x07060000
    v_mov_b32 v13, 0x0c0c0000
    v_cndmask_b32 v11, v13, v12, s[42:43]
    v_or_b32_e64 v148, v148, v11
    v_cndmask_b32 v11, v13, v12, s[46:47]
    v_or_b32_e64 v149, v149, v11
    v_xor_b32 v150, 0x0b0a0f0e, v148
    v_xor_b32 v151, 0x0b0a0f0e, v149
    s_mov_b32 s48, 0x3eb8aa3b
    s_mov_b32 s49, s48
    v_lshrrev_b32 v10, 1, v3
    s_lshl_b32 s51, s3, 1
    v_or_b32 v10, s51, v10
    v_and_b32 v11, 7, v2
    v_xor_b32 v10, v10, v11
    v_lshlrev_b32_e64 v10, 4, v10
    v_lshl_add_u32 v10, v2, 7, v10
    v_and_b32_e64 v11, 1, v3
    v_lshl_add_u32 v10, v11, 3, v10
    v_add_u32 v10, 69632, v10
    v_lshrrev_b32 v11, 3, v1
    v_and_b32 v12, 7, v1
    s_lshl_b32 s51, s3, 3
    v_add_u32 v13, s51, v11
    v_xor_b32 v14, v12, v11
    v_lshlrev_b32 v14, 4, v14
    v_lshl_add_u32 v14, v13, 7, v14
    v_add_u32 v14, 69632, v14
    v_add_u32_e64 v15, s37, v13
    v_lshl_add_u32 v15, v15, 1, s32
    v_and_b32 v11, 31, v15
    v_lshrrev_b32 v15, 5, v15
    v_mul_u32_u24 v11, 65536, v11
    v_lshl_add_u32 v15, v15, 7, v11
    v_lshl_add_u32 v15, v12, 4, v15
    s_lshl_b32 s53, s36, 13
    s_mul_i32 s51, s34, 73
    s_sub_u32 s51, s51, s37
    s_add_u32 s51, s51, 7
    s_cmp_eq_u32 s34, 0
    s_cselect_b32 s51, 0, s51
    v_cmp_le_u32 s[54:55], s51, v13
    v_mov_b32 v152, 0x3f803f80
    v_mov_b32 v153, 0x3f803f80
    v_mov_b32 v154, 0x3f803f80
    v_mov_b32 v155, 0x3f803f80
    v_mov_b32 v180, 0
    v_mov_b32 v181, 0
    v_mov_b32 v7, v4
    v_mov_b32 v8, v5
    v_mov_b32 v9, v6
    s_mov_b32 s51, 0
    s_mov_b32 s52, 0
    s_waitcnt lgkmcnt(0)
    s_barrier
    ds_read_b64_tr_b16 v[96:97], v9 offset:10240
    ds_read_b64_tr_b16 v[98:99], v9 offset:10752
    ds_read_b128 v[76:79], v7 offset:0
    ds_read_b64_tr_b16 v[100:101], v9 offset:18432
    ds_read_b64_tr_b16 v[102:103], v9 offset:18944
    ds_read_b128 v[80:83], v7 offset:2048
    ds_read_b64_tr_b16 v[104:105], v9 offset:26624
    ds_read_b64_tr_b16 v[106:107], v9 offset:27136
    ds_read_b128 v[84:87], v7 offset:4096
    ds_read_b128 v[88:91], v7 offset:6144
    ds_read_b128 v[92:95], v7 offset:8192
.p2align 3
L_main:
    s_waitcnt lgkmcnt(0)
    s_add_u32 s51, s51, 1
    v_mfma_f32_16x16x32_bf16 v[16:19], v[96:99], v[76:79], v[16:19]
    ds_read_b64_tr_b16 v[128:129], v9 offset:14336
    v_mfma_f32_16x16x32_bf16 v[36:39], v[100:103], v[76:79], v[36:39]
    ds_read_b64_tr_b16 v[130:131], v9 offset:14848
    v_mfma_f32_16x16x32_bf16 v[56:59], v[76:79], v[104:107], v[56:59]
    ds_read_b128 v[108:111], v8 offset:0
    v_mfma_f32_16x16x32_bf16 v[20:23], v[96:99], v[80:83], v[20:23]
    ds_read_b64_tr_b16 v[132:133], v9 offset:22528
    v_mfma_f32_16x16x32_bf16 v[40:43], v[100:103], v[80:83], v[40:43]
    ds_read_b64_tr_b16 v[134:135], v9 offset:23040
    v_mfma_f32_16x16x32_bf16 v[60:63], v[80:83], v[104:107], v[60:63]
    ds_read_b128 v[112:115], v8 offset:2048
    v_mfma_f32_16x16x32_bf16 v[24:27], v[96:99], v[84:87], v[24:27]
    ds_read_b64_tr_b16 v[136:137], v9 offset:30720
    v_mfma_f32_16x16x32_bf16 v[44:47], v[100:103], v[84:87], v[44:47]
    ds_read_b64_tr_b16 v[138:139], v9 offset:31232
    v_mfma_f32_16x16x32_bf16 v[64:67], v[84:87], v[104:107], v[64:67]
    ds_read_b128 v[116:119], v8 offset:4096
    v_mfma_f32_16x16x32_bf16 v[28:31], v[96:99], v[88:91], v[28:31]
    ds_read_b128 v[120:123], v8 offset:6144
    v_mfma_f32_16x16x32_bf16 v[48:51], v[100:103], v[88:91], v[48:51]
    ds_read_b128 v[124:127], v8 offset:8192
    v_mfma_f32_16x16x32_bf16 v[68:71], v[88:91], v[104:107], v[68:71]
    v_mfma_f32_16x16x32_bf16 v[32:35], v[96:99], v[92:95], v[32:35]
    v_mfma_f32_16x16x32_bf16 v[52:55], v[100:103], v[92:95], v[52:55]
    v_mfma_f32_16x16x32_bf16 v[72:75], v[92:95], v[104:107], v[72:75]
    s_add_u32 s52, s52, 34816
    s_cmp_eq_u32 s52, 139264
    s_cselect_b32 s52, 0, s52
    s_waitcnt lgkmcnt(0)
    s_barrier
    v_add_u32 v7, s52, v4
    v_add_u32_e64 v9, s52, v6
    v_add_u32 v8, s52, v5
    s_cmp_lt_u32 s51, 7
    v_mfma_f32_16x16x32_bf16 v[16:19], v[128:131], v[108:111], v[16:19]
    ds_read_b64_tr_b16 v[96:97], v9 offset:10240
    v_mfma_f32_16x16x32_bf16 v[36:39], v[132:135], v[108:111], v[36:39]
    ds_read_b64_tr_b16 v[98:99], v9 offset:10752
    v_mfma_f32_16x16x32_bf16 v[56:59], v[108:111], v[136:139], v[56:59]
    ds_read_b128 v[76:79], v7 offset:0
    v_mfma_f32_16x16x32_bf16 v[20:23], v[128:131], v[112:115], v[20:23]
    ds_read_b64_tr_b16 v[100:101], v9 offset:18432
    v_mfma_f32_16x16x32_bf16 v[40:43], v[132:135], v[112:115], v[40:43]
    ds_read_b64_tr_b16 v[102:103], v9 offset:18944
    v_mfma_f32_16x16x32_bf16 v[60:63], v[112:115], v[136:139], v[60:63]
    ds_read_b128 v[80:83], v7 offset:2048
    v_mfma_f32_16x16x32_bf16 v[24:27], v[128:131], v[116:119], v[24:27]
    ds_read_b64_tr_b16 v[104:105], v9 offset:26624
    v_mfma_f32_16x16x32_bf16 v[44:47], v[132:135], v[116:119], v[44:47]
    ds_read_b64_tr_b16 v[106:107], v9 offset:27136
    v_mfma_f32_16x16x32_bf16 v[64:67], v[116:119], v[136:139], v[64:67]
    ds_read_b128 v[84:87], v7 offset:4096
    v_mfma_f32_16x16x32_bf16 v[28:31], v[128:131], v[120:123], v[28:31]
    ds_read_b128 v[88:91], v7 offset:6144
    v_mfma_f32_16x16x32_bf16 v[48:51], v[132:135], v[120:123], v[48:51]
    ds_read_b128 v[92:95], v7 offset:8192
    v_mfma_f32_16x16x32_bf16 v[68:71], v[120:123], v[136:139], v[68:71]
    v_mfma_f32_16x16x32_bf16 v[32:35], v[128:131], v[124:127], v[32:35]
    v_mfma_f32_16x16x32_bf16 v[52:55], v[132:135], v[124:127], v[52:55]
    v_mfma_f32_16x16x32_bf16 v[72:75], v[124:127], v[136:139], v[72:75]
    s_cbranch_scc1 L_main
    s_waitcnt lgkmcnt(0)
    v_mfma_f32_16x16x32_bf16 v[16:19], v[96:99], v[76:79], v[16:19]
    ds_read_b64_tr_b16 v[128:129], v9 offset:14336
    v_mfma_f32_16x16x32_bf16 v[36:39], v[100:103], v[76:79], v[36:39]
    ds_read_b64_tr_b16 v[130:131], v9 offset:14848
    v_mfma_f32_16x16x32_bf16 v[20:23], v[96:99], v[80:83], v[20:23]
    ds_read_b128 v[108:111], v8 offset:0
    v_mfma_f32_16x16x32_bf16 v[40:43], v[100:103], v[80:83], v[40:43]
    ds_read_b64_tr_b16 v[132:133], v9 offset:22528
    v_mfma_f32_16x16x32_bf16 v[24:27], v[96:99], v[84:87], v[24:27]
    ds_read_b64_tr_b16 v[134:135], v9 offset:23040
    v_mfma_f32_16x16x32_bf16 v[44:47], v[100:103], v[84:87], v[44:47]
    ds_read_b128 v[112:115], v8 offset:2048
    v_mfma_f32_16x16x32_bf16 v[28:31], v[96:99], v[88:91], v[28:31]
    ds_read_b64_tr_b16 v[136:137], v9 offset:30720
    v_mfma_f32_16x16x32_bf16 v[48:51], v[100:103], v[88:91], v[48:51]
    ds_read_b64_tr_b16 v[138:139], v9 offset:31232
    v_mfma_f32_16x16x32_bf16 v[32:35], v[96:99], v[92:95], v[32:35]
    ds_read_b128 v[116:119], v8 offset:4096
    v_mfma_f32_16x16x32_bf16 v[52:55], v[100:103], v[92:95], v[52:55]
    ds_read_b128 v[120:123], v8 offset:6144
    ds_read_b128 v[124:127], v8 offset:8192
    v_mfma_f32_16x16x32_bf16 v[56:59], v[76:79], v[104:107], v[56:59]
    v_mfma_f32_16x16x32_bf16 v[60:63], v[80:83], v[104:107], v[60:63]
    s_waitcnt lgkmcnt(0)
    s_nop 0
    v_mfma_f32_16x16x32_bf16 v[16:19], v[128:131], v[108:111], v[16:19]
    v_mfma_f32_16x16x32_bf16 v[36:39], v[132:135], v[108:111], v[36:39]
    v_mfma_f32_16x16x32_bf16 v[20:23], v[128:131], v[112:115], v[20:23]
    v_mfma_f32_16x16x32_bf16 v[40:43], v[132:135], v[112:115], v[40:43]
    v_mfma_f32_16x16x32_bf16 v[24:27], v[128:131], v[116:119], v[24:27]
    v_mfma_f32_16x16x32_bf16 v[44:47], v[132:135], v[116:119], v[44:47]
    s_nop 2
    s_nop 0
    v_cvt_pk_bf16_f32 v160, v16, v17
    v_cvt_pk_bf16_f32 v161, v18, v19
    v_mfma_f32_16x16x32_bf16 v[28:31], v[128:131], v[120:123], v[28:31]
    v_cvt_pk_bf16_f32 v170, v36, v37
    v_cvt_pk_bf16_f32 v171, v38, v39
    v_mfma_f32_16x16x32_bf16 v[48:51], v[132:135], v[120:123], v[48:51]
    v_cvt_pk_bf16_f32 v162, v20, v21
    v_cvt_pk_bf16_f32 v163, v22, v23
    v_mfma_f32_16x16x32_bf16 v[32:35], v[128:131], v[124:127], v[32:35]
    v_cvt_pk_bf16_f32 v172, v40, v41
    v_cvt_pk_bf16_f32 v173, v42, v43
    v_mfma_f32_16x16x32_bf16 v[52:55], v[132:135], v[124:127], v[52:55]
    v_cvt_pk_bf16_f32 v164, v24, v25
    v_cvt_pk_bf16_f32 v165, v26, v27
    v_mfma_f32_16x16x16_bf16 v[16:19], v[170:171], v[160:161], v[140:143]
    v_cvt_pk_bf16_f32 v174, v44, v45
    v_cvt_pk_bf16_f32 v175, v46, v47
    v_mfma_f32_16x16x16_bf16 v[20:23], v[172:173], v[162:163], v[140:143]
    v_cvt_pk_bf16_f32 v166, v28, v29
    v_cvt_pk_bf16_f32 v167, v30, v31
    v_mfma_f32_16x16x16_bf16 v[40:43], v[170:171], v[162:163], v[144:147]
    v_cvt_pk_bf16_f32 v176, v48, v49
    v_cvt_pk_bf16_f32 v177, v50, v51
    v_mfma_f32_16x16x32_bf16 v[64:67], v[84:87], v[104:107], v[64:67]
    v_cvt_pk_bf16_f32 v168, v32, v33
    v_cvt_pk_bf16_f32 v169, v34, v35
    v_mfma_f32_16x16x16_bf16 v[24:27], v[174:175], v[164:165], v[140:143]
    v_cvt_pk_bf16_f32 v178, v52, v53
    v_cvt_pk_bf16_f32 v179, v54, v55
    v_mfma_f32_16x16x16_bf16 v[44:47], v[172:173], v[164:165], v[144:147]
    v_mfma_f32_16x16x16_bf16 v[28:31], v[176:177], v[166:167], v[140:143]
    v_mfma_f32_16x16x16_bf16 v[48:51], v[174:175], v[166:167], v[144:147]
    v_mfma_f32_16x16x16_bf16 v[32:35], v[178:179], v[168:169], v[140:143]
    v_mfma_f32_16x16x16_bf16 v[52:55], v[176:177], v[168:169], v[144:147]
    v_max3_f32 v232, v16, v17, v18
    v_max_f32 v232, v232, v19
    v_max_f32 v20, v40, v20
    v_max_f32_e64 v21, v41, v21
    v_mfma_f32_16x16x32_bf16 v[68:71], v[88:91], v[104:107], v[68:71]
    v_max_f32 v22, v42, v22
    v_max_f32 v23, v43, v23
    v_max3_f32 v233, v20, v21, v22
    v_max_f32_e64 v233, v233, v23
    v_mfma_f32_16x16x32_bf16 v[72:75], v[92:95], v[104:107], v[72:75]
    v_max_f32 v24, v44, v24
    v_max_f32 v25, v45, v25
    v_max_f32 v26, v46, v26
    v_max_f32 v27, v47, v27
    v_mfma_f32_16x16x32_bf16 v[56:59], v[108:111], v[136:139], v[56:59]
    v_max3_f32 v234, v24, v25, v26
    v_max_f32 v234, v234, v27
    v_max_f32 v28, v48, v28
    v_max_f32_e64 v29, v49, v29
    v_mfma_f32_16x16x32_bf16 v[60:63], v[112:115], v[136:139], v[60:63]
    v_max_f32 v30, v50, v30
    v_max_f32 v31, v51, v31
    v_max3_f32 v235, v28, v29, v30
    v_max_f32_e64 v235, v235, v31
    v_mfma_f32_16x16x32_bf16 v[64:67], v[116:119], v[136:139], v[64:67]
    v_max_f32 v32, v52, v32
    v_max_f32 v33, v53, v33
    v_max_f32 v34, v54, v34
    v_max_f32 v35, v55, v35
    v_mfma_f32_16x16x32_bf16 v[68:71], v[120:123], v[136:139], v[68:71]
    v_max3_f32 v236, v32, v33, v34
    v_max_f32_e64 v236, v236, v35
    v_mfma_f32_16x16x32_bf16 v[72:75], v[124:127], v[136:139], v[72:75]
    v_mov_b32 v242, v236
    v_permlane32_swap_b32 v232, v233
    v_permlane32_swap_b32 v234, v235
    v_permlane32_swap_b32 v242, v236
    v_max_f32 v232, v232, v233
    v_max_f32 v234, v234, v235
    v_max_f32 v236, v236, v242
    s_nop 0
    v_permlane16_swap_b32 v232, v234
    v_mov_b32 v242, v236
    v_max_f32 v232, v232, v234
    v_mul_f32 v232, s48, v232
    v_permlane16_swap_b32 v242, v236
    v_mov_b32 v234, v232
    v_max_f32 v236, v236, v242
    v_mul_f32 v246, s48, v236
    v_permlane16_swap_b32 v232, v234
    v_mov_b32 v238, v234
    v_mov_b32 v240, v232
    s_nop 0
    v_permlane32_swap_b32 v234, v238
    v_permlane32_swap_b32 v232, v240
    v_pk_fma_f32 v[32:33], v[32:33], s[48:49], v[246:247] op_sel_hi:[1,1,0] neg_lo:[0,0,1] neg_hi:[0,0,1]
    v_pk_fma_f32 v[34:35], v[34:35], s[48:49], v[246:247] op_sel_hi:[1,1,0] neg_lo:[0,0,1] neg_hi:[0,0,1]
    v_exp_f32 v32, v32
    v_exp_f32 v33, v33
    v_exp_f32 v34, v34
    v_exp_f32 v35, v35
    v_cvt_pk_bf16_f32 v188, v68, v69
    v_cvt_pk_bf16_f32 v189, v70, v71
    v_pk_fma_f32 v[16:17], v[16:17], s[48:49], v[232:233] op_sel_hi:[1,1,0] neg_lo:[0,0,1] neg_hi:[0,0,1]
    v_pk_fma_f32 v[18:19], v[18:19], s[48:49], v[232:233] op_sel_hi:[1,1,0] neg_lo:[0,0,1] neg_hi:[0,0,1]
    v_exp_f32 v16, v16
    v_exp_f32 v17, v17
    v_exp_f32 v18, v18
    v_exp_f32 v19, v19
    v_cvt_pk_bf16_f32 v190, v72, v73
    v_cvt_pk_bf16_f32 v191, v74, v75
    v_pk_fma_f32 v[20:21], v[20:21], s[48:49], v[240:241] op_sel_hi:[1,1,0] neg_lo:[0,0,1] neg_hi:[0,0,1]
    v_pk_fma_f32 v[22:23], v[22:23], s[48:49], v[240:241] op_sel_hi:[1,1,0] neg_lo:[0,0,1] neg_hi:[0,0,1]
    v_exp_f32 v20, v20
    v_exp_f32 v21, v21
    v_exp_f32 v22, v22
    v_exp_f32 v23, v23
    v_cvt_pk_bf16_f32 v182, v56, v57
    v_cvt_pk_bf16_f32 v183, v58, v59
    v_pk_fma_f32 v[24:25], v[24:25], s[48:49], v[234:235] op_sel_hi:[1,1,0] neg_lo:[0,0,1] neg_hi:[0,0,1]
    v_pk_fma_f32 v[26:27], v[26:27], s[48:49], v[234:235] op_sel_hi:[1,1,0] neg_lo:[0,0,1] neg_hi:[0,0,1]
    v_exp_f32 v24, v24
    v_exp_f32 v25, v25
    v_exp_f32 v26, v26
    v_exp_f32 v27, v27
    v_cvt_pk_bf16_f32 v184, v60, v61
    v_cvt_pk_bf16_f32 v185, v62, v63
    v_pk_fma_f32 v[28:29], v[28:29], s[48:49], v[238:239] op_sel_hi:[1,1,0] neg_lo:[0,0,1] neg_hi:[0,0,1]
    v_pk_fma_f32 v[30:31], v[30:31], s[48:49], v[238:239] op_sel_hi:[1,1,0] neg_lo:[0,0,1] neg_hi:[0,0,1]
    v_exp_f32 v28, v28
    v_exp_f32 v29, v29
    v_exp_f32 v30, v30
    v_exp_f32 v31, v31
    v_cvt_pk_bf16_f32 v186, v64, v65
    v_cvt_pk_bf16_f32 v187, v66, v67
    v_perm_b32 v208, v33, v32, v150
    v_perm_b32 v209, v35, v34, v151
    v_perm_b32 v210, v33, v32, v148
    v_perm_b32 v211, v35, v34, v149
    v_perm_b32 v192, v17, v16, v150
    v_perm_b32 v193, v19, v18, v151
    v_mfma_f32_16x16x32_bf16 v[228:231], v[152:155], v[208:211], 0
    v_perm_b32 v194, v17, v16, v148
    v_perm_b32 v195, v19, v18, v149
    v_mfma_f32_16x16x32_bf16 v[52:55], v[188:191], v[208:211], 0
    v_perm_b32 v196, v21, v20, v150
    v_perm_b32 v197, v23, v22, v151
    v_mfma_f32_16x16x32_bf16 v[212:215], v[152:155], v[192:195], 0
    v_perm_b32 v198, v21, v20, v148
    v_perm_b32 v199, v23, v22, v149
    v_mfma_f32_16x16x32_bf16 v[36:39], v[180:183], v[192:195], 0
    v_perm_b32 v200, v25, v24, v150
    v_perm_b32 v201, v27, v26, v151
    v_mfma_f32_16x16x32_bf16 v[216:219], v[152:155], v[196:199], 0
    v_perm_b32 v202, v25, v24, v148
    v_perm_b32 v203, v27, v26, v149
    v_mfma_f32_16x16x32_bf16 v[40:43], v[182:185], v[196:199], 0
    v_perm_b32 v204, v29, v28, v150
    v_perm_b32 v205, v31, v30, v151
    v_mfma_f32_16x16x32_bf16 v[220:223], v[152:155], v[200:203], 0
    v_perm_b32 v206, v29, v28, v148
    v_perm_b32 v207, v31, v30, v149
    v_mfma_f32_16x16x32_bf16 v[44:47], v[184:187], v[200:203], 0
    v_rcp_f32_e64 v228, v228
    v_mfma_f32_16x16x32_bf16 v[224:227], v[152:155], v[204:207], 0
    v_mfma_f32_16x16x32_bf16 v[48:51], v[186:189], v[204:207], 0
    v_rcp_f32_e64 v212, v212
    v_pk_mul_f32 v[52:53], v[52:53], v[228:229] op_sel_hi:[1,0]
    v_pk_mul_f32 v[54:55], v[54:55], v[228:229] op_sel_hi:[1,0]
    v_cvt_pk_bf16_f32 v52, v52, v53
    v_cvt_pk_bf16_f32 v53, v54, v55
    ds_write_b64 v10, v[52:53] offset:8192
    v_rcp_f32_e64 v216, v216
    v_pk_mul_f32 v[36:37], v[36:37], v[212:213] op_sel_hi:[1,0]
    v_pk_mul_f32 v[38:39], v[38:39], v[212:213] op_sel_hi:[1,0]
    v_cvt_pk_bf16_f32 v36, v36, v37
    v_cvt_pk_bf16_f32 v37, v38, v39
    ds_write_b64 v10, v[36:37] offset:0
    v_rcp_f32_e64 v220, v220
    v_pk_mul_f32 v[40:41], v[40:41], v[216:217] op_sel_hi:[1,0]
    v_pk_mul_f32 v[42:43], v[42:43], v[216:217] op_sel_hi:[1,0]
    v_cvt_pk_bf16_f32 v40, v40, v41
    v_cvt_pk_bf16_f32 v41, v42, v43
    ds_write_b64 v10, v[40:41] offset:2048
    v_rcp_f32_e64 v224, v224
    v_pk_mul_f32 v[44:45], v[44:45], v[220:221] op_sel_hi:[1,0]
    v_pk_mul_f32 v[46:47], v[46:47], v[220:221] op_sel_hi:[1,0]
    v_cvt_pk_bf16_f32 v44, v44, v45
    v_cvt_pk_bf16_f32 v45, v46, v47
    ds_write_b64 v10, v[44:45] offset:4096
    v_pk_mul_f32 v[48:49], v[48:49], v[224:225] op_sel_hi:[1,0]
    v_pk_mul_f32 v[50:51], v[50:51], v[224:225] op_sel_hi:[1,0]
    v_cvt_pk_bf16_f32 v48, v48, v49
    v_cvt_pk_bf16_f32 v49, v50, v51
    ds_write_b64 v10, v[48:49] offset:6144
    v_mov_b32 v248, 155648
    v_mov_b32 v249, 1
    s_mov_b64 exec, 1
    ds_add_u32 v248, v249 offset:0
    s_mov_b64 exec, -1
    s_cmp_ge_u32 s3, 2
L_lwo:
    ds_read_b32 v249, v248
    ds_read_b128 v[216:219], v14 offset:8192
    ds_read_b128 v[208:211], v14 offset:4096
    ds_read_b128 v[212:215], v14
    s_waitcnt lgkmcnt(3)
    v_cmp_gt_u32 vcc, 4, v249
    s_cbranch_vccnz L_lwo
    s_cbranch_scc1 L_ost1
    s_waitcnt lgkmcnt(2)
    buffer_store_dwordx4 v[216:219], v15, s[16:19], s53 offen offset:512 sc1
L_ost1:
    s_waitcnt lgkmcnt(1)
    buffer_store_dwordx4 v[208:211], v15, s[16:19], s53 offen offset:256 sc1
    s_waitcnt lgkmcnt(0)
    s_mov_b64 exec, s[54:55]
    buffer_store_dwordx4 v[212:215], v15, s[16:19], s53 offen sc1
    s_mov_b64 exec, -1
    s_mov_b32 s49, 0
L_p2b:
    s_mov_b32 s52, s30
    s_lshl_b32 s52, s52, 1
    s_lshr_b32 s53, s31, 4
    s_add_u32 s52, s52, s53
    s_bfe_u32 s53, s31, 65539
    s_sub_u32 s51, 32, s52
    s_cmp_eq_u32 s52, 0
    s_cselect_b32 s51, 16, s51
    s_cselect_b32 s54, 0, s53
    s_cselect_b32 s55, s53, 0
    s_cmp_eq_u32 s53, 0
    s_cselect_b32 s51, s52, s51
    s_lshl_b32 s55, s55, 4
    s_add_u32 s52, s52, s55
    s_mov_b32 s53, s54
    v_and_b32 v2, 15, v1
    v_lshrrev_b32 v3, 4, v1
    v_lshrrev_b32 v4, 3, v2
    v_and_b32 v5, 1, v3
    v_lshl_or_b32 v4, v5, 1, v4
    v_lshlrev_b32 v4, 5, v4
    v_and_b32 v5, 3, v2
    v_lshl_add_u32 v4, v5, 3, v4
    v_lshrrev_b32_e64 v5, 2, v2
    v_lshl_add_u32 v5, v3, 3, v5
    v_lshl_add_u32 v4, v5, 7, v4
    v_xor_b32 v5, 32, v4
    v_xor_b32 v6, 64, v4
    v_xor_b32 v7, 0x60, v4
    s_cmp_eq_u32 s49, 1
    s_cbranch_scc1 L_prew
    v_mov_b32 v248, 155648
    ds_read_b32 v249, v248 offset:8
    s_waitcnt lgkmcnt(0)
    v_cmp_gt_u32 vcc, 2, v249
    s_cbranch_vccnz L_drain
    s_branch L_pre
L_prew:
    v_mov_b32 v248, 155648
L_lww:
    ds_read_b32 v249, v248 offset:8
    s_waitcnt lgkmcnt(0)
    v_cmp_gt_u32 vcc, 2, v249
    s_cbranch_vccnz L_lww
L_pre:
    s_nop 0
    ds_read_b64_tr_b16 v[16:17], v4 offset:0
    ds_read_b64_tr_b16 v[18:19], v4 offset:512
    ds_read_b64_tr_b16 v[20:21], v5 offset:0
    ds_read_b64_tr_b16 v[22:23], v5 offset:512
    ds_read_b64_tr_b16 v[24:25], v6 offset:0
    ds_read_b64_tr_b16 v[26:27], v6 offset:512
    ds_read_b64_tr_b16 v[28:29], v7 offset:0
    ds_read_b64_tr_b16 v[30:31], v7 offset:512
    ds_read_b64_tr_b16 v[32:33], v4 offset:4096
    ds_read_b64_tr_b16 v[34:35], v4 offset:4608
    ds_read_b64_tr_b16 v[36:37], v5 offset:4096
    ds_read_b64_tr_b16 v[38:39], v5 offset:4608
    ds_read_b64_tr_b16 v[40:41], v6 offset:4096
    ds_read_b64_tr_b16 v[42:43], v6 offset:4608
    ds_read_b64_tr_b16 v[44:45], v7 offset:4096
    ds_read_b64_tr_b16 v[46:47], v7 offset:4608
    s_waitcnt lgkmcnt(8)
    s_nop 0
    ds_read_b64_tr_b16 v[48:49], v4 offset:8192
    ds_read_b64_tr_b16 v[50:51], v4 offset:8704
    ds_read_b64_tr_b16 v[52:53], v5 offset:8192
    ds_read_b64_tr_b16 v[54:55], v5 offset:8704
    ds_read_b64_tr_b16 v[56:57], v6 offset:8192
    ds_read_b64_tr_b16 v[58:59], v6 offset:8704
    ds_read_b64_tr_b16 v[60:61], v7 offset:8192
    ds_read_b64_tr_b16 v[62:63], v7 offset:8704
    s_waitcnt lgkmcnt(8)
    s_nop 0
    ds_read_b64_tr_b16 v[64:65], v4 offset:12288
    ds_read_b64_tr_b16 v[66:67], v4 offset:12800
    ds_read_b64_tr_b16 v[68:69], v5 offset:12288
    ds_read_b64_tr_b16 v[70:71], v5 offset:12800
    ds_read_b64_tr_b16 v[72:73], v6 offset:12288
    ds_read_b64_tr_b16 v[74:75], v6 offset:12800
    ds_read_b64_tr_b16 v[76:77], v7 offset:12288
    ds_read_b64_tr_b16 v[78:79], v7 offset:12800
    s_waitcnt lgkmcnt(8)
    s_nop 0
    ds_read_b64_tr_b16 v[80:81], v4 offset:16384
    ds_read_b64_tr_b16 v[82:83], v4 offset:16896
    ds_read_b64_tr_b16 v[84:85], v5 offset:16384
    ds_read_b64_tr_b16 v[86:87], v5 offset:16896
    ds_read_b64_tr_b16 v[88:89], v6 offset:16384
    ds_read_b64_tr_b16 v[90:91], v6 offset:16896
    ds_read_b64_tr_b16 v[92:93], v7 offset:16384
    ds_read_b64_tr_b16 v[94:95], v7 offset:16896
    s_waitcnt lgkmcnt(8)
    s_cmp_eq_u32 s49, 1
    s_cbranch_scc1 L_after
    s_mov_b32 s49, 2
L_drain:
    s_waitcnt vmcnt(0)
    v_mov_b32 v248, 155648
    v_mov_b32 v249, 1
    s_mov_b64 exec, 1
    ds_add_rtn_u32 v249, v248, v249 offset:4
    ds_read_b32 v245, v248 offset:16
    s_waitcnt lgkmcnt(0)
    v_cmp_eq_u32_e64 vcc, 3, v249
    s_mov_b64 exec, -1
    s_cbranch_vccz L_nosig
    v_readfirstlane_b32 s44, v245
    s_nop 0
    s_cmp_lg_u32 s44, 0
    s_cbranch_scc1 L_sig
    v_mov_b32 v248, 155648
L_lws:
    ds_read_b32 v249, v248 offset:16
    s_waitcnt lgkmcnt(0)
    v_cmp_gt_u32 vcc, 1, v249
    s_cbranch_vccnz L_lws
L_sig:
    s_lshr_b32 s40, s31, 1
    s_lshl_b32 s41, s32, 8
    s_add_u32 s40, s40, s41
    s_lshl_b32 s40, s40, 7
    s_add_u32 s40, s40, 5242624
    v_lshlrev_b32 v243, 11, v1
    s_mov_b64 exec, 0xffff
    v_mov_b32_e64 v244, 1
    buffer_atomic_add v244, v243, s[16:19], s40 offen
    s_mov_b64 exec, -1
L_nosig:
    s_cmp_eq_u32 s49, 2
    s_cbranch_scc1 L_after
    s_mov_b32 s49, 1
    s_branch L_prew
L_after:
    s_nop 0
    ds_read_b64_tr_b16 v[96:97], v4 offset:20480
    ds_read_b64_tr_b16 v[98:99], v4 offset:20992
    ds_read_b64_tr_b16 v[100:101], v5 offset:20480
    ds_read_b64_tr_b16 v[102:103], v5 offset:20992
    ds_read_b64_tr_b16 v[104:105], v6 offset:20480
    ds_read_b64_tr_b16 v[106:107], v6 offset:20992
    ds_read_b64_tr_b16 v[108:109], v7 offset:20480
    ds_read_b64_tr_b16 v[110:111], v7 offset:20992
    v_lshrrev_b32 v8, 4, v1
    v_and_b32 v9, 7, v1
    v_xor_b32 v8, v8, v9
    v_lshlrev_b32 v8, 4, v8
    v_lshrrev_b32_e64 v9, 3, v1
    v_lshl_add_u32 v8, v9, 7, v8
    s_mul_i32 s40, s51, 65536
    s_lshl_b32 s41, s3, 11
    s_add_u32 s40, s40, s41
    ds_read_b64_tr_b16 v[112:113], v4 offset:24576
    ds_read_b64_tr_b16 v[114:115], v4 offset:25088
    ds_read_b64_tr_b16 v[116:117], v5 offset:24576
    ds_read_b64_tr_b16 v[118:119], v5 offset:25088
    ds_read_b64_tr_b16 v[120:121], v6 offset:24576
    ds_read_b64_tr_b16 v[122:123], v6 offset:25088
    ds_read_b64_tr_b16 v[124:125], v7 offset:24576
    ds_read_b64_tr_b16 v[126:127], v7 offset:25088
    v_add_u32 v8, s40, v8
    v_xor_b32 v240, 64, v8
    v_lshrrev_b32 v15, 1, v2
    s_lshl_b32 s56, s3, 6
    s_add_u32 s56, s56, 155712
    v_lshl_add_u32 v9, v2, 2, s56
    s_lshl_b32 s57, s3, 14
    s_add_u32 s57, s57, 65536
    v_xor_b32 v12, v15, v3
    s_waitcnt lgkmcnt(8)
    s_nop 0
    ds_read_b64_tr_b16 v[128:129], v4 offset:28672
    ds_read_b64_tr_b16 v[130:131], v4 offset:29184
    ds_read_b64_tr_b16 v[132:133], v5 offset:28672
    ds_read_b64_tr_b16 v[134:135], v5 offset:29184
    ds_read_b64_tr_b16 v[136:137], v6 offset:28672
    ds_read_b64_tr_b16 v[138:139], v6 offset:29184
    ds_read_b64_tr_b16 v[140:141], v7 offset:28672
    ds_read_b64_tr_b16 v[142:143], v7 offset:29184
    v_lshlrev_b32_e64 v12, 4, v12
    v_lshl_add_u32 v12, v2, 7, v12
    v_add_u32 v12, s57, v12
    v_xor_b32 v13, 64, v12
    v_lshrrev_b32 v10, 1, v3
    v_and_b32 v11, 1, v3
    v_lshl_or_b32 v10, v11, 1, v10
    v_and_b32_e64 v11, 7, v2
    v_xor_b32 v10, v10, v11
    s_waitcnt lgkmcnt(8)
    ds_read_b64_tr_b16 v[144:145], v4 offset:32768
    ds_read_b64_tr_b16 v[146:147], v4 offset:33280
    ds_read_b64_tr_b16 v[148:149], v5 offset:32768
    ds_read_b64_tr_b16 v[150:151], v5 offset:33280
    ds_read_b64_tr_b16 v[152:153], v6 offset:32768
    ds_read_b64_tr_b16 v[154:155], v6 offset:33280
    ds_read_b64_tr_b16 v[156:157], v7 offset:32768
    ds_read_b64_tr_b16 v[158:159], v7 offset:33280
    v_lshlrev_b32_e64 v10, 4, v10
    v_lshl_add_u32 v10, v2, 7, v10
    v_add_u32 v10, s57, v10
    v_xor_b32 v242, 64, v10
    v_lshrrev_b32 v14, 3, v1
    v_and_b32 v241, 7, v1
    v_xor_b32 v11, v14, v241
    v_lshlrev_b32 v11, 4, v11
    v_lshl_add_u32 v11, v14, 7, v11
    s_waitcnt lgkmcnt(8)
    s_nop 0
    ds_read_b64_tr_b16 v[160:161], v4 offset:36864
    ds_read_b64_tr_b16 v[162:163], v4 offset:37376
    ds_read_b64_tr_b16 v[164:165], v5 offset:36864
    ds_read_b64_tr_b16 v[166:167], v5 offset:37376
    ds_read_b64_tr_b16 v[168:169], v6 offset:36864
    ds_read_b64_tr_b16 v[170:171], v6 offset:37376
    ds_read_b64_tr_b16 v[172:173], v7 offset:36864
    ds_read_b64_tr_b16 v[174:175], v7 offset:37376
    v_add_u32 v11, s57, v11
    s_lshl_b32 s41, s3, 4
    v_add_u32_e64 v14, s41, v14
    v_lshl_add_u32 v14, v14, 5, s51
    v_lshlrev_b32_e64 v14, 10, v14
    v_lshl_add_u32 v241, v241, 4, v14
    s_lshl_b32 s41, s3, 12
    s_add_u32 s41, s41, 139264
    v_lshl_add_u32 v14, v1, 4, s41
    s_waitcnt lgkmcnt(8)
    ds_read_b64_tr_b16 v[176:177], v4 offset:40960
    ds_read_b64_tr_b16 v[178:179], v4 offset:41472
    ds_read_b64_tr_b16 v[180:181], v5 offset:40960
    ds_read_b64_tr_b16 v[182:183], v5 offset:41472
    ds_read_b64_tr_b16 v[184:185], v6 offset:40960
    ds_read_b64_tr_b16 v[186:187], v6 offset:41472
    ds_read_b64_tr_b16 v[188:189], v7 offset:40960
    ds_read_b64_tr_b16 v[190:191], v7 offset:41472
    s_lshl_b32 s46, s50, 7
    s_add_u32 s47, s46, 262144
    v_mov_b32 v224, 0
    v_mov_b32 v225, 0
    v_mov_b32 v226, 0
    v_mov_b32 v227, 0
    v_mov_b32 v228, 0
    v_mov_b32_e64 v229, 0
    v_mov_b32 v230, 0
    s_waitcnt lgkmcnt(8)
    ds_read_b64_tr_b16 v[192:193], v4 offset:45056
    ds_read_b64_tr_b16 v[194:195], v4 offset:45568
    ds_read_b64_tr_b16 v[196:197], v5 offset:45056
    ds_read_b64_tr_b16 v[198:199], v5 offset:45568
    ds_read_b64_tr_b16 v[200:201], v6 offset:45056
    ds_read_b64_tr_b16 v[202:203], v6 offset:45568
    ds_read_b64_tr_b16 v[204:205], v7 offset:45056
    ds_read_b64_tr_b16 v[206:207], v7 offset:45568
    v_mov_b32 v231, 0
    v_mov_b32 v232, 0
    v_mov_b32 v233, 0
    v_mov_b32 v234, 0
    v_mov_b32 v235, 0
    v_mov_b32 v236, 0
    v_mov_b32 v237, 0
    v_mov_b32 v238, 0
    v_mov_b32 v239, 0
    s_waitcnt lgkmcnt(8)
    s_lshl_b32 s48, s50, 13
    s_mov_b32 m0, s57
    v_mov_b32 v248, 155648
L_lwg:
    ds_read_b32 v249, v248 offset:20
    s_waitcnt lgkmcnt(0)
    v_cmp_gt_u32 vcc, 1, v249
    s_cbranch_vccnz L_lwg
    buffer_load_dwordx4 v8, s[16:19], s48 offen sc1 lds
    buffer_load_dwordx4 v240, s[16:19], s48 offen offset:1024 sc1 lds
    s_addk_i32 m0, 2048
    s_add_u32 s48, s48, 8192
    s_and_b32 s48, s48, 0xffff
    buffer_load_dwordx4 v8, s[16:19], s48 offen sc1 lds
    buffer_load_dwordx4 v240, s[16:19], s48 offen offset:1024 sc1 lds
    s_addk_i32 m0, 2048
    s_add_u32 s48, s48, 8192
    s_and_b32 s48, s48, 0xffff
    buffer_load_dwordx4 v8, s[16:19], s48 offen sc1 lds
    buffer_load_dwordx4 v240, s[16:19], s48 offen offset:1024 sc1 lds
    s_addk_i32 m0, 2048
    s_add_u32 s48, s48, 8192
    s_and_b32 s48, s48, 0xffff
    buffer_load_dwordx4 v8, s[16:19], s48 offen sc1 lds
    buffer_load_dwordx4 v240, s[16:19], s48 offen offset:1024 sc1 lds
    s_waitcnt lgkmcnt(0)
    s_waitcnt vmcnt(6)
    ds_read_b128 v[208:211], v12 offset:0
    ds_read_b128 v[212:215], v13 offset:0
    s_waitcnt lgkmcnt(1)
    v_mfma_f32_16x16x32_bf16 v[224:227], v[16:19], v[208:211], v[224:227]
    v_mfma_f32_16x16x32_bf16 v[228:231], v[20:23], v[208:211], v[228:231]
    s_waitcnt vmcnt(4)
    ds_read_b128 v[216:219], v12 offset:2048
    v_mfma_f32_16x16x32_bf16 v[232:235], v[24:27], v[208:211], v[232:235]
    ds_read_b128 v[220:223], v13 offset:2048
    v_mfma_f32_16x16x32_bf16 v[236:239], v[28:31], v[208:211], v[236:239]
    s_waitcnt lgkmcnt(2)
    v_mfma_f32_16x16x32_bf16 v[224:227], v[32:35], v[212:215], v[224:227]
    s_addk_i32 m0, 2048
    s_add_u32 s48, s48, 8192
    s_and_b32 s48, s48, 0xffff
    buffer_load_dwordx4 v8, s[16:19], s48 offen sc1 lds
    buffer_load_dwordx4 v240, s[16:19], s48 offen offset:1024 sc1 lds
    v_mfma_f32_16x16x32_bf16 v[228:231], v[36:39], v[212:215], v[228:231]
    ds_read_b64_tr_b16 v[16:17], v4 offset:49152
    v_mfma_f32_16x16x32_bf16 v[232:235], v[40:43], v[212:215], v[232:235]
    ds_read_b64_tr_b16 v[18:19], v4 offset:49664
    v_mfma_f32_16x16x32_bf16 v[236:239], v[44:47], v[212:215], v[236:239]
    ds_read_b64_tr_b16 v[20:21], v5 offset:49152
    s_waitcnt lgkmcnt(4)
    v_mfma_f32_16x16x32_bf16 v[224:227], v[48:51], v[216:219], v[224:227]
    ds_read_b64_tr_b16 v[22:23], v5 offset:49664
    v_mfma_f32_16x16x32_bf16 v[228:231], v[52:55], v[216:219], v[228:231]
    s_waitcnt vmcnt(4)
    ds_read_b128 v[208:211], v12 offset:4096
    v_mfma_f32_16x16x32_bf16 v[232:235], v[56:59], v[216:219], v[232:235]
    ds_read_b128 v[212:215], v13 offset:4096
    v_mfma_f32_16x16x32_bf16 v[236:239], v[60:63], v[216:219], v[236:239]
    ds_read_b64_tr_b16 v[24:25], v6 offset:49152
    s_waitcnt lgkmcnt(7)
    v_mfma_f32_16x16x32_bf16 v[224:227], v[64:67], v[220:223], v[224:227]
    s_addk_i32 m0, 2048
    s_add_u32 s48, s48, 8192
    s_and_b32 s48, s48, 0xffff
    buffer_load_dwordx4 v8, s[16:19], s48 offen sc1 lds
    buffer_load_dwordx4 v240, s[16:19], s48 offen offset:1024 sc1 lds
    v_mfma_f32_16x16x32_bf16 v[228:231], v[68:71], v[220:223], v[228:231]
    ds_read_b64_tr_b16 v[26:27], v6 offset:49664
    v_mfma_f32_16x16x32_bf16 v[232:235], v[72:75], v[220:223], v[232:235]
    ds_read_b64_tr_b16 v[28:29], v7 offset:49152
    v_mfma_f32_16x16x32_bf16 v[236:239], v[76:79], v[220:223], v[236:239]
    ds_read_b64_tr_b16 v[30:31], v7 offset:49664
    s_waitcnt lgkmcnt(5)
    v_mfma_f32_16x16x32_bf16 v[224:227], v[80:83], v[208:211], v[224:227]
    ds_read_b64_tr_b16 v[32:33], v4 offset:53248
    v_mfma_f32_16x16x32_bf16 v[228:231], v[84:87], v[208:211], v[228:231]
    s_waitcnt vmcnt(4)
    ds_read_b128 v[216:219], v12 offset:6144
    v_mfma_f32_16x16x32_bf16 v[232:235], v[88:91], v[208:211], v[232:235]
    ds_read_b128 v[220:223], v13 offset:6144
    v_mfma_f32_16x16x32_bf16 v[236:239], v[92:95], v[208:211], v[236:239]
    ds_read_b64_tr_b16 v[34:35], v4 offset:53760
    s_waitcnt lgkmcnt(8)
    v_mfma_f32_16x16x32_bf16 v[224:227], v[96:99], v[212:215], v[224:227]
    s_addk_i32 m0, 2048
    s_add_u32 s48, s48, 8192
    s_and_b32 s48, s48, 0xffff
    buffer_load_dwordx4 v8, s[16:19], s48 offen sc1 lds
    buffer_load_dwordx4 v240, s[16:19], s48 offen offset:1024 sc1 lds
    v_mfma_f32_16x16x32_bf16 v[228:231], v[100:103], v[212:215], v[228:231]
    ds_read_b64_tr_b16 v[36:37], v5 offset:53248
    v_mfma_f32_16x16x32_bf16 v[232:235], v[104:107], v[212:215], v[232:235]
    ds_read_b64_tr_b16 v[38:39], v5 offset:53760
    v_mfma_f32_16x16x32_bf16 v[236:239], v[108:111], v[212:215], v[236:239]
    ds_read_b64_tr_b16 v[40:41], v6 offset:53248
    s_waitcnt lgkmcnt(5)
    v_mfma_f32_16x16x32_bf16 v[224:227], v[112:115], v[216:219], v[224:227]
    ds_read_b64_tr_b16 v[42:43], v6 offset:53760
    v_mfma_f32_16x16x32_bf16 v[228:231], v[116:119], v[216:219], v[228:231]
    s_waitcnt vmcnt(4)
    ds_read_b128 v[208:211], v12 offset:8192
    v_mfma_f32_16x16x32_bf16 v[232:235], v[120:123], v[216:219], v[232:235]
    ds_read_b128 v[212:215], v13 offset:8192
    v_mfma_f32_16x16x32_bf16 v[236:239], v[124:127], v[216:219], v[236:239]
    ds_read_b64_tr_b16 v[44:45], v7 offset:53248
    s_waitcnt lgkmcnt(8)
    v_mfma_f32_16x16x32_bf16 v[224:227], v[128:131], v[220:223], v[224:227]
    s_addk_i32 m0, 2048
    s_add_u32 s48, s48, 8192
    s_and_b32 s48, s48, 0xffff
    buffer_load_dwordx4 v8, s[16:19], s48 offen sc1 lds
    buffer_load_dwordx4 v240, s[16:19], s48 offen offset:1024 sc1 lds
    v_mfma_f32_16x16x32_bf16 v[228:231], v[132:135], v[220:223], v[228:231]
    ds_read_b64_tr_b16 v[46:47], v7 offset:53760
    v_mfma_f32_16x16x32_bf16 v[232:235], v[136:139], v[220:223], v[232:235]
    ds_read_b64_tr_b16 v[48:49], v4 offset:57344
    v_mfma_f32_16x16x32_bf16 v[236:239], v[140:143], v[220:223], v[236:239]
    ds_read_b64_tr_b16 v[50:51], v4 offset:57856
    s_waitcnt lgkmcnt(5)
    v_mfma_f32_16x16x32_bf16 v[224:227], v[144:147], v[208:211], v[224:227]
    ds_read_b64_tr_b16 v[52:53], v5 offset:57344
    v_mfma_f32_16x16x32_bf16 v[228:231], v[148:151], v[208:211], v[228:231]
    s_waitcnt vmcnt(4)
    ds_read_b128 v[216:219], v12 offset:10240
    v_mfma_f32_16x16x32_bf16 v[232:235], v[152:155], v[208:211], v[232:235]
    ds_read_b128 v[220:223], v13 offset:10240
    v_mfma_f32_16x16x32_bf16 v[236:239], v[156:159], v[208:211], v[236:239]
    ds_read_b64_tr_b16 v[54:55], v5 offset:57856
    s_waitcnt lgkmcnt(8)
    s_nop 0
    v_mfma_f32_16x16x32_bf16 v[224:227], v[160:163], v[212:215], v[224:227]
    ds_read_b64_tr_b16 v[56:57], v6 offset:57344
    v_mfma_f32_16x16x32_bf16 v[228:231], v[164:167], v[212:215], v[228:231]
    ds_read_b64_tr_b16 v[58:59], v6 offset:57856
    v_mfma_f32_16x16x32_bf16 v[232:235], v[168:171], v[212:215], v[232:235]
    ds_read_b64_tr_b16 v[60:61], v7 offset:57344
    v_mfma_f32_16x16x32_bf16 v[236:239], v[172:175], v[212:215], v[236:239]
    ds_read_b64_tr_b16 v[62:63], v7 offset:57856
    s_waitcnt lgkmcnt(6)
    v_mfma_f32_16x16x32_bf16 v[224:227], v[176:179], v[216:219], v[224:227]
    ds_read_b64_tr_b16 v[64:65], v4 offset:61440
    v_mfma_f32_16x16x32_bf16 v[228:231], v[180:183], v[216:219], v[228:231]
    s_waitcnt vmcnt(2)
    ds_read_b128 v[208:211], v12 offset:12288
    v_mfma_f32_16x16x32_bf16 v[232:235], v[184:187], v[216:219], v[232:235]
    ds_read_b128 v[212:215], v13 offset:12288
    v_mfma_f32_16x16x32_bf16 v[236:239], v[188:191], v[216:219], v[236:239]
    ds_read_b64_tr_b16 v[66:67], v4 offset:61952
    s_waitcnt lgkmcnt(9)
    s_nop 0
    v_mfma_f32_16x16x32_bf16 v[224:227], v[192:195], v[220:223], v[224:227]
    ds_read_b64_tr_b16 v[68:69], v5 offset:61440
    v_mfma_f32_16x16x32_bf16 v[228:231], v[196:199], v[220:223], v[228:231]
    ds_read_b64_tr_b16 v[70:71], v5 offset:61952
    v_mfma_f32_16x16x32_bf16 v[232:235], v[200:203], v[220:223], v[232:235]
    ds_read_b64_tr_b16 v[72:73], v6 offset:61440
    v_mfma_f32_16x16x32_bf16 v[236:239], v[204:207], v[220:223], v[236:239]
    ds_read_b64_tr_b16 v[74:75], v6 offset:61952
    ds_read_b64_tr_b16 v[76:77], v7 offset:61440
    ds_read_b64_tr_b16 v[78:79], v7 offset:61952
    s_waitcnt lgkmcnt(8)
    v_mfma_f32_16x16x32_bf16 v[224:227], v[16:19], v[208:211], v[224:227]
    ds_read_b32 v243, v248 offset:24
    v_mfma_f32_16x16x32_bf16 v[228:231], v[20:23], v[208:211], v[228:231]
    s_waitcnt vmcnt(0)
    ds_read_b128 v[216:219], v12 offset:14336
    v_mfma_f32_16x16x32_bf16 v[232:235], v[24:27], v[208:211], v[232:235]
    ds_read_b128 v[220:223], v13 offset:14336
    v_mfma_f32_16x16x32_bf16 v[236:239], v[28:31], v[208:211], v[236:239]
    ds_read_b32 v15, v9
    s_waitcnt lgkmcnt(11)
    s_nop 0
    v_mfma_f32_16x16x32_bf16 v[224:227], v[32:35], v[212:215], v[224:227]
    ds_read_b128 v[80:83], v14 offset:0
    v_mfma_f32_16x16x32_bf16 v[228:231], v[36:39], v[212:215], v[228:231]
    ds_read_b128 v[84:87], v14 offset:1024
    v_mfma_f32_16x16x32_bf16 v[232:235], v[40:43], v[212:215], v[232:235]
    ds_read_b128 v[88:91], v14 offset:2048
    v_mfma_f32_16x16x32_bf16 v[236:239], v[44:47], v[212:215], v[236:239]
    ds_read_b128 v[92:95], v14 offset:3072
    s_waitcnt lgkmcnt(0)
    v_cmp_le_u32 vcc, 2, v243
    s_cbranch_vccnz L_yearly
    s_waitcnt lgkmcnt(0)
    v_mfma_f32_16x16x32_bf16 v[224:227], v[48:51], v[216:219], v[224:227]
    v_mfma_f32_16x16x32_bf16 v[228:231], v[52:55], v[216:219], v[228:231]
    v_mfma_f32_16x16x32_bf16 v[224:227], v[64:67], v[220:223], v[224:227]
    v_mfma_f32_16x16x32_bf16 v[228:231], v[68:71], v[220:223], v[228:231]
    v_mfma_f32_16x16x32_bf16 v[232:235], v[56:59], v[216:219], v[232:235]
    v_mfma_f32_16x16x32_bf16 v[236:239], v[60:63], v[216:219], v[236:239]
    v_mfma_f32_16x16x32_bf16 v[232:235], v[72:75], v[220:223], v[232:235]
    v_mfma_f32_16x16x32_bf16 v[236:239], v[76:79], v[220:223], v[236:239]
L_ylate:
    ds_read_b32 v243, v248 offset:24
    ds_read_b32 v15, v9
    ds_read_b128 v[80:83], v14 offset:0
    ds_read_b128 v[84:87], v14 offset:1024
    ds_read_b128 v[88:91], v14 offset:2048
    ds_read_b128 v[92:95], v14 offset:3072
    s_waitcnt lgkmcnt(0)
    v_cmp_gt_u32 vcc, 2, v243
    s_cbranch_vccnz L_ylate
    v_sub_f32 v246, 1.0, v15
    v_mov_b32_e64 v244, v15
    v_pk_mul_f32 v[80:81], v[80:81], v[244:245] op_sel_hi:[1,0]
    v_pk_mul_f32 v[82:83], v[82:83], v[244:245] op_sel_hi:[1,0]
    v_pk_mul_f32 v[84:85], v[84:85], v[244:245] op_sel_hi:[1,0]
    v_pk_mul_f32 v[86:87], v[86:87], v[244:245] op_sel_hi:[1,0]
    v_pk_mul_f32 v[88:89], v[88:89], v[244:245] op_sel_hi:[1,0]
    v_pk_mul_f32 v[90:91], v[90:91], v[244:245] op_sel_hi:[1,0]
    v_pk_mul_f32 v[92:93], v[92:93], v[244:245] op_sel_hi:[1,0]
    v_pk_mul_f32 v[94:95], v[94:95], v[244:245] op_sel_hi:[1,0]
    v_pk_fma_f32 v[80:81], v[224:225], v[246:247], v[80:81] op_sel_hi:[1,0,1]
    v_pk_fma_f32 v[82:83], v[226:227], v[246:247], v[82:83] op_sel_hi:[1,0,1]
    v_pk_fma_f32 v[84:85], v[228:229], v[246:247], v[84:85] op_sel_hi:[1,0,1]
    v_pk_fma_f32 v[86:87], v[230:231], v[246:247], v[86:87] op_sel_hi:[1,0,1]
    s_branch L_yjoin
L_yearly:
    v_sub_f32 v246, 1.0, v15
    v_mul_f32 v80, v15, v80
    v_mul_f32 v81, v15, v81
    v_mul_f32 v82, v15, v82
    v_mul_f32 v83, v15, v83
    v_mul_f32 v84, v15, v84
    v_mul_f32 v85, v15, v85
    v_mul_f32 v86, v15, v86
    v_mul_f32 v87, v15, v87
    v_mfma_f32_16x16x32_bf16 v[224:227], v[48:51], v[216:219], v[224:227]
    v_mul_f32 v88, v15, v88
    v_mul_f32 v89, v15, v89
    v_mfma_f32_16x16x32_bf16 v[228:231], v[52:55], v[216:219], v[228:231]
    v_mul_f32 v90, v15, v90
    v_mul_f32 v91, v15, v91
    v_mfma_f32_16x16x32_bf16 v[224:227], v[64:67], v[220:223], v[224:227]
    v_mul_f32 v92, v15, v92
    v_mul_f32 v93, v15, v93
    v_mfma_f32_16x16x32_bf16 v[228:231], v[68:71], v[220:223], v[228:231]
    v_mul_f32 v94, v15, v94
    v_mul_f32 v95, v15, v95
    v_mfma_f32_16x16x32_bf16 v[232:235], v[56:59], v[216:219], v[232:235]
    v_mfma_f32_16x16x32_bf16 v[236:239], v[60:63], v[216:219], v[236:239]
    v_mfma_f32_16x16x32_bf16 v[232:235], v[72:75], v[220:223], v[232:235]
    v_fma_f32 v80, v224, v246, v80
    v_fma_f32 v81, v225, v246, v81
    v_fma_f32 v82, v226, v246, v82
    v_fma_f32 v83, v227, v246, v83
    v_mfma_f32_16x16x32_bf16 v[236:239], v[76:79], v[220:223], v[236:239]
    v_fma_f32 v84, v228, v246, v84
    v_fma_f32 v85, v229, v246, v85
    v_fma_f32 v86, v230, v246, v86
    v_fma_f32 v87, v231, v246, v87
L_yjoin:
    v_cvt_pk_bf16_f32 v96, v80, v81
    v_cvt_pk_bf16_f32 v97, v82, v83
    v_cvt_pk_bf16_f32 v98, v84, v85
    v_cvt_pk_bf16_f32 v99, v86, v87
    s_nop 0
    v_permlane16_swap_b32 v96, v98
    v_permlane16_swap_b32 v97, v99
    s_nop 0
    ds_write_b128 v10, v[96:99]
    v_fma_f32 v88, v232, v246, v88
    v_fma_f32 v89, v233, v246, v89
    v_fma_f32 v90, v234, v246, v90
    v_fma_f32 v91, v235, v246, v91
    v_fma_f32 v92, v236, v246, v92
    v_fma_f32 v93, v237, v246, v93
    v_fma_f32 v94, v238, v246, v94
    v_fma_f32 v95, v239, v246, v95
    v_cvt_pk_bf16_f32 v100, v88, v89
    v_cvt_pk_bf16_f32 v101, v90, v91
    v_cvt_pk_bf16_f32 v102, v92, v93
    v_cvt_pk_bf16_f32 v103, v94, v95
    s_nop 0
    v_permlane16_swap_b32 v100, v102
    v_permlane16_swap_b32 v101, v103
    ds_write_b128 v242, v[100:103]
    ds_read_b128 v[24:27], v11
    ds_read_b128 v[28:31], v11 offset:1024
    s_waitcnt lgkmcnt(1)
    buffer_store_dwordx4 v[24:27], v241, s[20:23], s46 offen sc1
    s_waitcnt lgkmcnt(0)
    buffer_store_dwordx4 v[28:31], v241, s[20:23], s47 offen sc1
    s_endpgm
L_yfft:
    s_mov_b32 s52, s30
    s_lshl_b32 s52, s52, 1
    s_lshr_b32 s53, s31, 4
    s_add_u32 s52, s52, s53
    s_bfe_u32 s53, s31, 65539
    s_sub_u32 s51, 32, s52
    s_cmp_eq_u32 s52, 0
    s_cselect_b32 s51, 16, s51
    s_cselect_b32 s54, 0, s53
    s_cselect_b32 s55, s53, 0
    s_cmp_eq_u32 s53, 0
    s_cselect_b32 s51, s52, s51
    s_lshl_b32 s55, s55, 4
    s_add_u32 s52, s52, s55
    s_mov_b32 s53, s54
    v_and_b32 v2, 15, v1
    v_lshrrev_b32 v3, 4, v1
    s_and_b32 s41, s3, 1
    s_lshl_b32 s40, s41, 5
    s_lshl_b32 s42, s50, 6
    s_add_u32 s40, s40, s42
    s_cmp_lg_u32 s53, 0
    s_cselect_b64 vcc, -1, 0
    v_sub_u32 v6, 15, v2
    v_cndmask_b32 v6, v2, v6, vcc
    v_add_u32 v4, s40, v2
    s_add_u32 s40, s40, 16
    v_sub_u32 v7, 512, v4
    v_and_b32 v7, 511, v7
    v_cndmask_b32 v4, v4, v7, vcc
    v_lshrrev_b32 v7, 6, v4
    v_and_b32 v4, 63, v4
    v_lshlrev_b32 v4, 2, v4
    v_lshl_add_u32 v4, v7, 13, v4
    v_lshl_add_u32 v4, v3, 11, v4
    v_add_u32 v5, s40, v2
    s_add_u32 s40, s40, 16
    v_sub_u32 v7, 512, v5
    v_and_b32 v7, 511, v7
    v_cndmask_b32 v5, v5, v7, vcc
    v_lshrrev_b32 v7, 6, v5
    v_and_b32 v5, 63, v5
    v_lshlrev_b32 v5, 2, v5
    v_lshl_add_u32 v5, v7, 13, v5
    v_lshl_add_u32 v5, v3, 11, v5
    s_lshl_b32 s46, s52, 16
    s_add_u32 s46, s46, 2359296
    s_lshl_b32 s40, s41, 11
    s_add_u32 s40, s40, 139264
    s_mul_i32 s42, s53, 12288
    s_add_u32 s40, s40, s42
    v_lshl_add_u32 v12, v1, 4, s40
    s_mul_i32 s42, s53, -8192
    s_add_u32 s42, s42, 4096
    v_add_u32 v13, s42, v12
    v_add_u32 v14, s42, v13
    v_add_u32 v15, s42, v14
    v_and_b32_e64 v240, 1, v2
    v_lshl_add_u32 v240, v240, 5, s51
    v_lshlrev_b32 v240, 7, v240
    v_lshrrev_b32 v241, 1, v2
    v_lshl_add_u32 v240, v241, 2, v240
    v_lshlrev_b32_e64 v241, 2, v2
    v_add_u32 v241, 155712, v241
    s_mov_b32 s48, 4718592
    v_lshlrev_b32_e64 v242, 31, v6
    v_or_b32 v242, 0x3f003f00, v242
    v_cvt_f32_u32_e64 v6, v6
    v_mul_f32 v6, 0x3c800000, v6
    v_cvt_f32_u32_e64 v7, v3
    v_mul_f32 v7, 0x41000000, v7
    v_mul_f32 v7, v7, v6
    v_cmp_eq_u32 vcc, 0, v3
    v_fmamk_f32 v8, v6, 0x00000000, v7
    v_fmamk_f32 v10, v6, 0x40000000, v7
    v_cos_f32 v9, v8
    v_sin_f32 v8, v8
    v_cos_f32 v11, v10
    v_sin_f32 v10, v10
    v_cvt_pk_bf16_f32 v16, v9, v8
    v_cvt_pk_bf16_f32 v17, v11, v10
    v_fmamk_f32 v8, v6, 0x40800000, v7
    v_fmamk_f32 v10, v6, 0x40c00000, v7
    v_cos_f32 v9, v8
    v_sin_f32 v8, v8
    v_cos_f32 v11, v10
    v_sin_f32 v10, v10
    v_cvt_pk_bf16_f32 v18, v9, v8
    v_cvt_pk_bf16_f32 v19, v11, v10
    v_fmamk_f32 v8, v6, 0x3f800000, v7
    v_fmamk_f32 v10, v6, 0x40400000, v7
    v_cos_f32 v9, v8
    v_sin_f32 v8, v8
    v_cos_f32 v11, v10
    v_sin_f32 v10, v10
    v_cvt_pk_bf16_f32 v20, v9, v8
    v_cvt_pk_bf16_f32 v21, v11, v10
    v_fmamk_f32 v8, v6, 0x40a00000, v7
    v_fmamk_f32 v10, v6, 0x40e00000, v7
    v_cos_f32 v9, v8
    v_sin_f32 v8, v8
    v_cos_f32 v11, v10
    v_sin_f32 v10, v10
    v_cvt_pk_bf16_f32 v22, v9, v8
    v_cvt_pk_bf16_f32 v23, v11, v10
    v_cndmask_b32 v16, v16, v242, vcc
    v_mov_b32 v32, v16
    v_alignbit_b32 v8, v20, v20, 16
    v_xor_b32 v40, 0x00008000, v8
    v_xor_b32 v33, 0x80008000, v17
    v_alignbit_b32 v8, v21, v21, 16
    v_xor_b32 v41, 0x80000000, v8
    v_mov_b32_e64 v34, v18
    v_alignbit_b32 v8, v22, v22, 16
    v_xor_b32 v42, 0x00008000, v8
    v_xor_b32 v35, 0x80008000, v19
    v_alignbit_b32 v8, v23, v23, 16
    v_xor_b32 v43, 0x80000000, v8
    s_branch L_yw7
L_ypoll:
    s_cmp_eq_u32 s3, 7
    s_cbranch_scc1 L_yw7
    v_mov_b32 v10, 0
    s_mov_b32 s45, 0
L_chky:
    global_load_dword v11, v10, s[26:27] sc1
    s_add_u32 s45, s45, 1
    s_cmp_gt_u32 s45, 100000
    s_cbranch_scc1 L_chkdy
    s_waitcnt vmcnt(0)
    v_cmp_gt_u32 vcc, 16, v11
    s_cbranch_vccnz L_chky
L_chkdy:
    v_mov_b32 v248, 155648
    v_mov_b32 v249, 1
    s_mov_b64 exec, 1
    ds_add_u32 v248, v249 offset:16
    s_mov_b64 exec, -1
    v_mov_b32 v248, 155648
L_lwz:
    ds_read_b32 v249, v248 offset:4
    s_waitcnt lgkmcnt(0)
    v_cmp_gt_u32 vcc, 4, v249
    s_cbranch_vccnz L_lwz
    s_lshl_b32 s40, s30, 2
    s_lshr_b32 s41, s31, 3
    s_add_u32 s40, s40, s41
    s_lshl_b32 s40, s40, 9
    s_add_u32 s40, s40, 5308416
    v_lshlrev_b32 v243, 7, v1
    s_mov_b32 s45, 0
    s_mov_b64 exec, 15
L_pollf:
    v_mov_b32 v244, 0
    buffer_atomic_add v244, v243, s[16:19], s40 offen sc0
L_pollwf:
    s_add_u32 s45, s45, 1
    s_waitcnt vmcnt(0)
    v_cmp_gt_u32_e64 vcc, 8, v244
    s_cmp_ge_u32 s45, 100000
    s_cbranch_scc1 L_polldf
    s_and_b64 exec, exec, vcc
    s_cbranch_execnz L_pollf
L_polldf:
    s_mov_b64 exec, -1
    v_mov_b32 v248, 155648
    v_mov_b32 v249, 1
    s_mov_b64 exec, 1
    ds_add_u32 v248, v249 offset:12
    s_mov_b64 exec, -1
L_yw7:
    v_mov_b32 v248, 155648
L_lwy:
    ds_read_b32 v249, v248 offset:12
    s_waitcnt lgkmcnt(0)
    v_cmp_gt_u32_e64 vcc, 1, v249
    s_cbranch_vccnz L_lwy
    s_setprio 3
    buffer_load_dword v64, v4, s[16:19], s46 offen offset:0
    buffer_load_dword v65, v4, s[16:19], s46 offen offset:512
    buffer_load_dword v66, v4, s[16:19], s46 offen offset:1024
    buffer_load_dword v67, v4, s[16:19], s46 offen offset:1536
    buffer_load_dword v68, v4, s[16:19], s46 offen offset:256
    buffer_load_dword v69, v4, s[16:19], s46 offen offset:768
    buffer_load_dword v70, v4, s[16:19], s46 offen offset:1280
    buffer_load_dword v71, v4, s[16:19], s46 offen offset:1792
    buffer_load_dword v236, v240, s[16:19], s48 offen offset:0
    buffer_load_dword v237, v240, s[16:19], s48 offen offset:32
    buffer_load_dword v238, v240, s[16:19], s48 offen offset:64
    buffer_load_dword v239, v240, s[16:19], s48 offen offset:96
    buffer_load_dword v72, v5, s[16:19], s46 offen offset:0
    buffer_load_dword v73, v5, s[16:19], s46 offen offset:512
    buffer_load_dword v74, v5, s[16:19], s46 offen offset:1024
    buffer_load_dword v75, v5, s[16:19], s46 offen offset:1536
    buffer_load_dword v76, v5, s[16:19], s46 offen offset:256
    buffer_load_dword v77, v5, s[16:19], s46 offen offset:768
    buffer_load_dword v78, v5, s[16:19], s46 offen offset:1280
    buffer_load_dword v79, v5, s[16:19], s46 offen offset:1792
    s_waitcnt vmcnt(16)
    v_mfma_f32_16x16x32_bf16 v[96:99], v[64:67], v[16:19], 0
    v_mfma_f32_16x16x32_bf16 v[100:103], v[64:67], v[32:35], 0
    s_waitcnt vmcnt(12)
    v_mfma_f32_16x16x32_bf16 v[104:107], v[68:71], v[20:23], 0
    v_mfma_f32_16x16x32_bf16 v[108:111], v[68:71], v[40:43], 0
    s_waitcnt vmcnt(4)
    v_mfma_f32_16x16x32_bf16 v[112:115], v[72:75], v[16:19], 0
    v_mfma_f32_16x16x32_bf16 v[116:119], v[72:75], v[32:35], 0
    s_waitcnt vmcnt(0)
    v_mfma_f32_16x16x32_bf16 v[120:123], v[76:79], v[20:23], 0
    v_mfma_f32_16x16x32_bf16 v[124:127], v[76:79], v[40:43], 0
    ds_write_b32 v241, v236 offset:0
    ds_write_b32 v241, v237 offset:64
    ds_write_b32 v241, v238 offset:128
    ds_write_b32 v241, v239 offset:192
    v_add_f32 v128, v96, v104
    v_add_f32 v129, v97, v105
    v_add_f32 v130, v98, v106
    v_add_f32 v131, v99, v107
    ds_write_b128 v12, v[128:131] offset:0
    v_add_f32 v132, v100, v108
    v_add_f32 v133, v101, v109
    v_add_f32 v134, v102, v110
    v_add_f32 v135, v103, v111
    ds_write_b128 v13, v[132:135] offset:0
    v_sub_f32 v136, v96, v104
    v_sub_f32 v137, v97, v105
    v_sub_f32 v138, v98, v106
    v_sub_f32 v139, v99, v107
    ds_write_b128 v14, v[136:139] offset:0
    v_sub_f32 v140, v100, v108
    v_sub_f32 v141, v101, v109
    v_sub_f32 v142, v102, v110
    v_sub_f32 v143, v103, v111
    ds_write_b128 v15, v[140:143] offset:0
    v_add_f32 v128, v112, v120
    v_add_f32 v129, v113, v121
    v_add_f32 v130, v114, v122
    v_add_f32 v131, v115, v123
    ds_write_b128 v12, v[128:131] offset:1024
    v_add_f32 v132, v116, v124
    v_add_f32 v133, v117, v125
    v_add_f32 v134, v118, v126
    v_add_f32 v135, v119, v127
    ds_write_b128 v13, v[132:135] offset:1024
    v_sub_f32 v136, v112, v120
    v_sub_f32 v137, v113, v121
    v_sub_f32 v138, v114, v122
    v_sub_f32 v139, v115, v123
    ds_write_b128 v14, v[136:139] offset:1024
    v_sub_f32 v140, v116, v124
    v_sub_f32 v141, v117, v125
    v_sub_f32 v142, v118, v126
    v_sub_f32 v143, v119, v127
    ds_write_b128 v15, v[140:143] offset:1024
    v_mov_b32 v248, 155648
    v_mov_b32 v249, 1
    s_mov_b64 exec, 1
    ds_add_u32 v248, v249 offset:24
    s_mov_b64 exec, -1
L_enda:
L_exita:
    s_endpgm
.p2align 7
.type L_table,@object
L_table:
.long 0x3f803f80,0x3f803f80,0x3f803f80,0x3f803f80,0x3f7b3f80,0x3f553f6d,0xbf7bbf80,0xbf55bf6d
.long 0x3f6d3f80,0x3ec43f35,0x3f6d3f80,0x3ec43f35,0x3f553f80,0xbe483ec4,0xbf55bf80,0x3e48bec4
.long 0x3f353f80,0xbf350000,0x3f353f80,0xbf350000,0x3f0e3f80,0xbf7bbec4,0xbf0ebf80,0x3f7b3ec4
.long 0x3ec43f80,0xbf6dbf35,0x3ec43f80,0xbf6dbf35,0x3e483f80,0xbf0ebf6d,0xbe48bf80,0x3f0e3f6d
.long 0x00003f80,0x8000bf80,0x80003f80,0x8000bf80,0xbe483f80,0x3f0ebf6d,0x3e48bf80,0xbf0e3f6d
.long 0xbec43f80,0x3f6dbf35,0xbec43f80,0x3f6dbf35,0xbf0e3f80,0x3f7bbec4,0x3f0ebf80,0xbf7b3ec4
.long 0xbf353f80,0x3f358000,0xbf353f80,0x3f358000,0xbf553f80,0x3e483ec4,0x3f55bf80,0xbe48bec4
.long 0xbf6d3f80,0xbec43f35,0xbf6d3f80,0xbec43f35,0xbf7b3f80,0xbf553f6d,0x3f7bbf80,0x3f55bf6d
.long 0x3f803f80,0x3f803f80,0x3f803f80,0x3f803f80,0x3f0e3f35,0x3e483ec4,0xbf0ebf35,0xbe48bec4
.long 0xbec40000,0xbf6dbf35,0xbec40000,0xbf6dbf35,0xbf7bbf35,0xbf0ebf6d,0x3f7b3f35,0x3f0e3f6d
.long 0xbf35bf80,0x3f358000,0xbf35bf80,0x3f358000,0x3e48bf35,0x3f553f6d,0xbe483f35,0xbf55bf6d
.long 0x3f6d8000,0xbec43f35,0x3f6d8000,0xbec43f35,0x3f553f35,0xbf7bbec4,0xbf55bf35,0x3f7b3ec4
.long 0x00003f80,0x8000bf80,0x80003f80,0x8000bf80,0xbf553f35,0x3f7bbec4,0x3f55bf35,0xbf7b3ec4
.long 0xbf6d0000,0x3ec43f35,0xbf6d8000,0x3ec43f35,0xbe48bf35,0xbf553f6d,0x3e483f35,0x3f55bf6d
.long 0x3f35bf80,0xbf350000,0x3f35bf80,0xbf350000,0x3f7bbf35,0x3f0ebf6d,0xbf7b3f35,0xbf0e3f6d
.long 0x3ec48000,0x3f6dbf35,0x3ec48000,0x3f6dbf35,0xbf0e3f35,0xbe483ec4,0x3f0ebf35,0x3e48bec4
.long 0x3f803f80,0x3f803f80,0x3f803f80,0x3f803f80,0xbe480000,0xbf0ebec4,0x3e488000,0x3f0e3ec4
.long 0xbf6dbf80,0xbec4bf35,0xbf6dbf80,0xbec4bf35,0x3f0e8000,0x3f7b3f6d,0xbf0e0000,0xbf7bbf6d
.long 0x3f353f80,0xbf350000,0x3f353f80,0xbf358000,0xbf550000,0xbe48bf6d,0x3f558000,0x3e483f6d
.long 0xbec4bf80,0x3f6d3f35,0xbec4bf80,0x3f6d3f35,0x3f7b8000,0xbf553ec4,0xbf7b8000,0x3f55bec4
.long 0x00003f80,0x8000bf80,0x80003f80,0x8000bf80,0xbf7b0000,0x3f553ec4,0x3f7b8000,0xbf55bec4
.long 0x3ec4bf80,0xbf6d3f35,0x3ec4bf80,0xbf6d3f35,0x3f558000,0x3e48bf6d,0xbf550000,0xbe483f6d
.long 0xbf353f80,0x3f358000,0xbf353f80,0x3f358000,0xbf0e8000,0xbf7b3f6d,0x3f0e8000,0x3f7bbf6d
.long 0x3f6dbf80,0x3ec4bf35,0x3f6dbf80,0x3ec4bf35,0x3e488000,0x3f0ebec4,0xbe480000,0xbf0e3ec4
.long 0x3f803f80,0x3f803f80,0x3f803f80,0x3f803f80,0xbf55bf35,0xbf7bbf6d,0x3f553f35,0x3f7b3f6d
.long 0x3ec48000,0x3f6d3f35,0x3ec48000,0x3f6d3f35,0x3e483f35,0xbf55bec4,0xbe48bf35,0x3f553ec4
.long 0xbf35bf80,0x3f358000,0xbf35bf80,0x3f358000,0x3f7b3f35,0xbf0e3ec4,0xbf7bbf35,0x3f0ebec4
.long 0xbf6d0000,0x3ec4bf35,0xbf6d8000,0x3ec4bf35,0x3f0ebf35,0xbe483f6d,0xbf0e3f35,0x3e48bf6d
.long 0x80003f80,0x8000bf80,0x80003f80,0x8000bf80,0xbf0ebf35,0x3e483f6d,0x3f0e3f35,0xbe48bf6d
.long 0x3f6d8000,0xbec4bf35,0x3f6d8000,0xbec4bf35,0xbf7b3f35,0x3f0e3ec4,0x3f7bbf35,0xbf0ebec4
.long 0x3f35bf80,0xbf358000,0x3f35bf80,0xbf350000,0xbe483f35,0x3f55bec4,0x3e48bf35,0xbf553ec4
.long 0xbec48000,0xbf6d3f35,0xbec40000,0xbf6d3f35,0x3f55bf35,0x3f7bbf6d,0xbf553f35,0xbf7b3f6d
.long 0x00000000,0x00000000,0x00000000,0x00000000,0x3e480000,0x3f0e3ec4,0xbe480000,0xbf0ebec4
.long 0x3ec40000,0x3f6d3f35,0x3ec48000,0x3f6d3f35,0x3f0e0000,0x3f7b3f6d,0xbf0e0000,0xbf7bbf6d
.long 0x3f350000,0x3f353f80,0x3f358000,0x3f353f80,0x3f550000,0x3e483f6d,0xbf550000,0xbe48bf6d
.long 0x3f6d0000,0xbec43f35,0x3f6d8000,0xbec43f35,0x3f7b0000,0xbf553ec4,0xbf7b0000,0x3f55bec4
.long 0x3f800000,0xbf800000,0x3f808000,0xbf800000,0x3f7b0000,0xbf55bec4,0xbf7b0000,0x3f553ec4
.long 0x3f6d0000,0xbec4bf35,0x3f6d8000,0xbec4bf35,0x3f550000,0x3e48bf6d,0xbf550000,0xbe483f6d
.long 0x3f350000,0x3f35bf80,0x3f358000,0x3f35bf80,0x3f0e0000,0x3f7bbf6d,0xbf0e8000,0xbf7b3f6d
.long 0x3ec40000,0x3f6dbf35,0x3ec48000,0x3f6dbf35,0x3e480000,0x3f0ebec4,0xbe480000,0xbf0e3ec4
.long 0x00000000,0x00000000,0x00000000,0x00000000,0x3f553f35,0x3f7b3f6d,0xbf55bf35,0xbf7bbf6d
.long 0x3f6d3f80,0x3ec43f35,0x3f6d3f80,0x3ec43f35,0x3e483f35,0xbf55bec4,0xbe48bf35,0x3f553ec4
.long 0xbf350000,0xbf35bf80,0xbf350000,0xbf35bf80,0xbf7bbf35,0x3f0ebec4,0x3f7b3f35,0xbf0e3ec4
.long 0xbec4bf80,0x3f6d3f35,0xbec4bf80,0x3f6d3f35,0x3f0ebf35,0xbe483f6d,0xbf0e3f35,0x3e48bf6d
.long 0x3f808000,0xbf800000,0x3f808000,0xbf800000,0x3f0e3f35,0xbe48bf6d,0xbf0ebf35,0x3e483f6d
.long 0xbec43f80,0x3f6dbf35,0xbec43f80,0x3f6dbf35,0xbf7b3f35,0x3f0e3ec4,0x3f7bbf35,0xbf0ebec4
.long 0xbf350000,0xbf353f80,0xbf350000,0xbf353f80,0x3e48bf35,0xbf553ec4,0xbe483f35,0x3f55bec4
.long 0x3f6dbf80,0x3ec4bf35,0x3f6dbf80,0x3ec4bf35,0x3f55bf35,0x3f7bbf6d,0xbf553f35,0xbf7b3f6d
.long 0x00000000,0x00000000,0x00000000,0x00000000,0x3f7b3f80,0x3f553f6d,0xbf7bbf80,0xbf55bf6d
.long 0xbec40000,0xbf6dbf35,0xbec40000,0xbf6dbf35,0xbf55bf80,0x3e48bec4,0x3f553f80,0xbe483ec4
.long 0x3f358000,0x3f353f80,0x3f358000,0x3f353f80,0x3f0e3f80,0xbf7bbec4,0xbf0ebf80,0x3f7b3ec4
.long 0xbf6d0000,0x3ec4bf35,0xbf6d0000,0x3ec4bf35,0xbe48bf80,0x3f0e3f6d,0x3e483f80,0xbf0ebf6d
.long 0x3f808000,0xbf800000,0x3f808000,0xbf808000,0xbe483f80,0x3f0ebf6d,0x3e48bf80,0xbf0e3f6d
.long 0xbf6d0000,0x3ec43f35,0xbf6d0000,0x3ec43f35,0x3f0ebf80,0xbf7b3ec4,0xbf0e3f80,0x3f7bbec4
.long 0x3f358000,0x3f35bf80,0x3f358000,0x3f35bf80,0xbf553f80,0x3e483ec4,0x3f55bf80,0xbe48bec4
.long 0xbec40000,0xbf6d3f35,0xbec48000,0xbf6d3f35,0x3f7bbf80,0x3f55bf6d,0xbf7b3f80,0xbf553f6d
.long 0x00000000,0x00000000,0x00000000,0x00000000,0x3f0e3f35,0x3e483ec4,0xbf0ebf35,0xbe48bec4
.long 0xbf6dbf80,0xbec4bf35,0xbf6dbf80,0xbec4bf35,0x3f7b3f35,0x3f0e3f6d,0xbf7bbf35,0xbf0ebf6d
.long 0xbf350000,0xbf35bf80,0xbf350000,0xbf35bf80,0x3e48bf35,0x3f553f6d,0xbe483f35,0xbf55bf6d
.long 0x3ec43f80,0xbf6dbf35,0x3ec43f80,0xbf6dbf35,0xbf55bf35,0x3f7b3ec4,0x3f553f35,0xbf7bbec4
.long 0x3f808000,0xbf800000,0x3f808000,0xbf800000,0xbf553f35,0x3f7bbec4,0x3f55bf35,0xbf7b3ec4
.long 0x3ec4bf80,0xbf6d3f35,0x3ec4bf80,0xbf6d3f35,0x3e483f35,0x3f55bf6d,0xbe48bf35,0xbf553f6d
.long 0xbf350000,0xbf353f80,0xbf358000,0xbf353f80,0x3f7bbf35,0x3f0ebf6d,0xbf7b3f35,0xbf0e3f6d
.long 0xbf6d3f80,0xbec43f35,0xbf6d3f80,0xbec43f35,0x3f0ebf35,0x3e48bec4,0xbf0e3f35,0xbe483ec4
.long 0x3f803f80,0x3f803f80,0x3f803f80,0x3f803f80,0x3f6d3f80,0x3ec43f35,0xbec40000,0xbf6dbf35
.long 0x3f353f80,0xbf350000,0xbf35bf80,0x3f358000,0x3ec43f80,0xbf6dbf35,0x3f6d8000,0xbec43f35
.long 0x00003f80,0x8000bf80,0x00003f80,0x8000bf80,0xbec43f80,0x3f6dbf35,0xbf6d0000,0x3ec43f35
.long 0xbf353f80,0x3f358000,0x3f35bf80,0xbf350000,0xbf6d3f80,0xbec43f35,0x3ec48000,0x3f6dbf35
.long 0xbf803f80,0xbf803f80,0xbf803f80,0xbf803f80,0xbf6d3f80,0xbec43f35,0x3ec40000,0x3f6dbf35
.long 0xbf353f80,0x3f350000,0x3f35bf80,0xbf358000,0xbec43f80,0x3f6dbf35,0xbf6d8000,0x3ec43f35
.long 0x80003f80,0x0000bf80,0x80003f80,0x8000bf80,0x3ec43f80,0xbf6dbf35,0x3f6d8000,0xbec43f35
.long 0x3f353f80,0xbf358000,0xbf35bf80,0x3f358000,0x3f6d3f80,0x3ec43f35,0xbec48000,0xbf6dbf35
.long 0x3f803f80,0x3f803f80,0x3f803f80,0x3f803f80,0xbf6dbf80,0xbec4bf35,0x3ec48000,0x3f6d3f35
.long 0x3f353f80,0xbf350000,0xbf35bf80,0x3f358000,0xbec4bf80,0x3f6d3f35,0xbf6d0000,0x3ec4bf35
.long 0x00003f80,0x8000bf80,0x80003f80,0x8000bf80,0x3ec4bf80,0xbf6d3f35,0x3f6d8000,0xbec4bf35
.long 0xbf353f80,0x3f358000,0x3f35bf80,0xbf358000,0x3f6dbf80,0x3ec4bf35,0xbec48000,0xbf6d3f35
.long 0xbf803f80,0xbf803f80,0xbf803f80,0xbf803f80,0x3f6dbf80,0x3ec4bf35,0xbec48000,0xbf6d3f35
.long 0xbf353f80,0x3f358000,0x3f35bf80,0xbf358000,0x3ec4bf80,0xbf6d3f35,0x3f6d0000,0xbec4bf35
.long 0x80003f80,0x0000bf80,0x80003f80,0x0000bf80,0xbec4bf80,0x3f6d3f35,0xbf6d8000,0x3ec4bf35
.long 0x3f353f80,0xbf358000,0xbf35bf80,0x3f350000,0xbf6dbf80,0xbec4bf35,0x3ec40000,0x3f6d3f35
.long 0x00000000,0x00000000,0x00000000,0x00000000,0x3ec40000,0x3f6d3f35,0x3f6d3f80,0x3ec43f35
.long 0x3f350000,0x3f353f80,0xbf350000,0xbf35bf80,0x3f6d0000,0xbec43f35,0xbec4bf80,0x3f6d3f35
.long 0x3f800000,0xbf800000,0x3f808000,0xbf800000,0x3f6d0000,0xbec4bf35,0xbec43f80,0x3f6dbf35
.long 0x3f350000,0x3f35bf80,0xbf350000,0xbf353f80,0x3ec40000,0x3f6dbf35,0x3f6dbf80,0x3ec4bf35
.long 0x00000000,0x00008000,0x00008000,0x80008000,0xbec40000,0xbf6d3f35,0xbf6d3f80,0xbec43f35
.long 0xbf350000,0xbf353f80,0x3f350000,0x3f35bf80,0xbf6d0000,0x3ec43f35,0x3ec4bf80,0xbf6d3f35
.long 0xbf800000,0x3f800000,0xbf808000,0x3f808000,0xbf6d0000,0x3ec4bf35,0x3ec43f80,0xbf6dbf35
.long 0xbf350000,0xbf35bf80,0x3f358000,0x3f353f80,0xbec40000,0xbf6dbf35,0xbf6dbf80,0xbec4bf35
.long 0x00000000,0x00000000,0x00000000,0x00000000,0xbec40000,0xbf6dbf35,0xbf6dbf80,0xbec4bf35
.long 0x3f358000,0x3f353f80,0xbf350000,0xbf35bf80,0xbf6d0000,0x3ec4bf35,0x3ec43f80,0xbf6dbf35
.long 0x3f808000,0xbf800000,0x3f808000,0xbf808000,0xbf6d0000,0x3ec43f35,0x3ec4bf80,0xbf6d3f35
.long 0x3f358000,0x3f35bf80,0xbf358000,0xbf353f80,0xbec48000,0xbf6d3f35,0xbf6d3f80,0xbec43f35
.long 0x80008000,0x80008000,0x80008000,0x80008000,0x3ec48000,0x3f6dbf35,0x3f6dbf80,0x3ec4bf35
.long 0xbf358000,0xbf353f80,0x3f358000,0x3f35bf80,0x3f6d8000,0xbec4bf35,0xbec43f80,0x3f6dbf35
.long 0xbf808000,0x3f808000,0xbf808000,0x3f800000,0x3f6d8000,0xbec43f35,0xbec4bf80,0x3f6d3f35
.long 0xbf358000,0xbf35bf80,0x3f350000,0x3f353f80,0x3ec48000,0x3f6d3f35,0x3f6d3f80,0x3ec43f35
.long 0x00000000,0x00000000,0x00000000,0x00000000,0xbec40000,0xbf6dbf35,0xbf6dbf80,0xbec4bf35
.long 0xbf350000,0xbf35bf80,0x3f358000,0x3f353f80,0xbf6d0000,0x3ec4bf35,0x3ec43f80,0xbf6dbf35
.long 0xbf800000,0x3f808000,0xbf800000,0x3f808000,0xbf6d0000,0x3ec43f35,0x3ec4bf80,0xbf6d3f35
.long 0xbf350000,0xbf353f80,0x3f358000,0x3f35bf80,0xbec40000,0xbf6d3f35,0xbf6d3f80,0xbec43f35
.long 0x80000000,0x80000000,0x80000000,0x80008000,0x3ec40000,0x3f6dbf35,0x3f6dbf80,0x3ec4bf35
.long 0x3f350000,0x3f35bf80,0xbf358000,0xbf353f80,0x3f6d0000,0xbec4bf35,0xbec43f80,0x3f6dbf35
.long 0x3f800000,0xbf808000,0x3f808000,0xbf808000,0x3f6d0000,0xbec43f35,0xbec4bf80,0x3f6d3f35
.long 0x3f350000,0x3f353f80,0xbf358000,0xbf35bf80,0x3ec40000,0x3f6d3f35,0x3f6d3f80,0x3ec43f35
.long 0x00000000,0x00000000,0x00000000,0x00000000,0x3ec48000,0x3f6d3f35,0x3f6d3f80,0x3ec43f35
.long 0xbf350000,0xbf35bf80,0x3f358000,0x3f353f80,0x3f6d8000,0xbec43f35,0xbec4bf80,0x3f6d3f35
.long 0xbf800000,0x3f808000,0xbf808000,0x3f808000,0x3f6d8000,0xbec4bf35,0xbec43f80,0x3f6dbf35
.long 0xbf358000,0xbf353f80,0x3f358000,0x3f35bf80,0x3ec48000,0x3f6dbf35,0x3f6dbf80,0x3ec4bf35
.long 0x80008000,0x80008000,0x80008000,0x80008000,0xbec48000,0xbf6d3f35,0xbf6d3f80,0xbec43f35
.long 0x3f358000,0x3f35bf80,0xbf358000,0xbf353f80,0xbf6d8000,0x3ec43f35,0x3ec4bf80,0xbf6d3f35
.long 0x3f808000,0xbf808000,0x3f800000,0xbf808000,0xbf6d8000,0x3ec4bf35,0x3ec43f80,0xbf6dbf35
.long 0x3f358000,0x3f353f80,0xbf358000,0xbf35bf80,0xbec48000,0xbf6dbf35,0xbf6dbf80,0xbec4bf35
.long 0x3f803f80,0x3f803f80,0x3f803f80,0x3f803f80,0x3f6d3f80,0x3ec43f35,0xbec40000,0xbf6dbf35
.long 0x3f353f80,0xbf350000,0xbf35bf80,0x3f358000,0x3ec43f80,0xbf6dbf35,0x3f6d8000,0xbec43f35
.long 0x00003f80,0x8000bf80,0x00003f80,0x8000bf80,0xbec43f80,0x3f6dbf35,0xbf6d0000,0x3ec43f35
.long 0xbf353f80,0x3f358000,0x3f35bf80,0xbf350000,0xbf6d3f80,0xbec43f35,0x3ec48000,0x3f6dbf35
.long 0xbf803f80,0xbf803f80,0xbf803f80,0xbf803f80,0xbf6d3f80,0xbec43f35,0x3ec40000,0x3f6dbf35
.long 0xbf353f80,0x3f350000,0x3f35bf80,0xbf358000,0xbec43f80,0x3f6dbf35,0xbf6d8000,0x3ec43f35
.long 0x80003f80,0x0000bf80,0x80003f80,0x8000bf80,0x3ec43f80,0xbf6dbf35,0x3f6d8000,0xbec43f35
.long 0x3f353f80,0xbf358000,0xbf35bf80,0x3f358000,0x3f6d3f80,0x3ec43f35,0xbec48000,0xbf6dbf35
.long 0x3f803f80,0x3f803f80,0x3f803f80,0x3f803f80,0xbf6dbf80,0xbec4bf35,0x3ec48000,0x3f6d3f35
.long 0x3f353f80,0xbf350000,0xbf35bf80,0x3f358000,0xbec4bf80,0x3f6d3f35,0xbf6d0000,0x3ec4bf35
.long 0x00003f80,0x8000bf80,0x80003f80,0x8000bf80,0x3ec4bf80,0xbf6d3f35,0x3f6d8000,0xbec4bf35
.long 0xbf353f80,0x3f358000,0x3f35bf80,0xbf358000,0x3f6dbf80,0x3ec4bf35,0xbec48000,0xbf6d3f35
.long 0xbf803f80,0xbf803f80,0xbf803f80,0xbf803f80,0x3f6dbf80,0x3ec4bf35,0xbec48000,0xbf6d3f35
.long 0xbf353f80,0x3f358000,0x3f35bf80,0xbf358000,0x3ec4bf80,0xbf6d3f35,0x3f6d0000,0xbec4bf35
.long 0x80003f80,0x0000bf80,0x80003f80,0x0000bf80,0xbec4bf80,0x3f6d3f35,0xbf6d8000,0x3ec4bf35
.long 0x3f353f80,0xbf358000,0xbf35bf80,0x3f350000,0xbf6dbf80,0xbec4bf35,0x3ec40000,0x3f6d3f35
.long 0x3f803f80,0x3f803f80,0x3f803f80,0x3f803f80,0x3f353f6d,0x80003ec4,0xbf35bec4,0xbf80bf6d
.long 0x80003f35,0xbf80bf35,0x0000bf35,0x3f803f35,0xbf353ec4,0x0000bf6d,0x3f353f6d,0xbf80bec4
.long 0xbf808000,0x3f808000,0xbf808000,0x3f800000,0xbf35bec4,0x80003f6d,0x3f35bf6d,0xbf803ec4
.long 0x8000bf35,0xbf803f35,0x80003f35,0x3f80bf35,0x3f35bf6d,0x8000bec4,0xbf353ec4,0xbf803f6d
.long 0x3f80bf80,0x3f80bf80,0x3f80bf80,0x3f80bf80,0x3f35bf6d,0x8000bec4,0xbf353ec4,0xbf803f6d
.long 0x8000bf35,0xbf803f35,0x80003f35,0x3f80bf35,0xbf35bec4,0x00003f6d,0x3f35bf6d,0xbf803ec4
.long 0xbf800000,0x3f808000,0xbf800000,0x3f808000,0xbf353ec4,0x8000bf6d,0x3f353f6d,0xbf80bec4
.long 0x00003f35,0xbf80bf35,0x8000bf35,0x3f803f35,0x3f353f6d,0x00003ec4,0xbf35bec4,0xbf80bf6d
.long 0x3f803f80,0x3f803f80,0x3f803f80,0x3f803f80,0xbf35bf6d,0x0000bec4,0x3f353ec4,0x3f803f6d
.long 0x80003f35,0xbf80bf35,0x0000bf35,0x3f803f35,0x3f35bec4,0x80003f6d,0xbf35bf6d,0x3f803ec4
.long 0xbf808000,0x3f800000,0xbf808000,0x3f800000,0x3f353ec4,0x0000bf6d,0xbf353f6d,0x3f80bec4
.long 0x0000bf35,0xbf803f35,0x80003f35,0x3f80bf35,0xbf353f6d,0x80003ec4,0x3f35bec4,0x3f80bf6d
.long 0x3f80bf80,0x3f80bf80,0x3f80bf80,0x3f80bf80,0xbf353f6d,0x00003ec4,0x3f35bec4,0x3f80bf6d
.long 0x8000bf35,0xbf803f35,0x00003f35,0x3f80bf35,0x3f353ec4,0x8000bf6d,0xbf353f6d,0x3f80bec4
.long 0xbf808000,0x3f808000,0xbf800000,0x3f808000,0x3f35bec4,0x80003f6d,0xbf35bf6d,0x3f803ec4
.long 0x80003f35,0xbf80bf35,0x8000bf35,0x3f803f35,0xbf35bf6d,0x8000bec4,0x3f353ec4,0x3f803f6d
.long 0x00000000,0x00000000,0x00000000,0x00000000,0x3f353ec4,0x3f803f6d,0x3f353f6d,0x80003ec4
.long 0x3f803f35,0x80003f35,0xbf80bf35,0x0000bf35,0x3f353f6d,0xbf80bec4,0x3f35bec4,0x80003f6d
.long 0x80003f80,0x8000bf80,0x80003f80,0x0000bf80,0xbf353f6d,0x3f80bec4,0xbf35bec4,0x80003f6d
.long 0xbf803f35,0x80003f35,0x3f80bf35,0x8000bf35,0xbf353ec4,0xbf803f6d,0xbf353f6d,0x80003ec4
.long 0x80008000,0x80008000,0x80008000,0x80008000,0x3f35bec4,0x3f80bf6d,0x3f35bf6d,0x8000bec4
.long 0x3f80bf35,0x8000bf35,0xbf803f35,0x80003f35,0x3f35bf6d,0xbf803ec4,0x3f353ec4,0x8000bf6d
.long 0x8000bf80,0x00003f80,0x8000bf80,0x80003f80,0xbf35bf6d,0x3f803ec4,0xbf353ec4,0x8000bf6d
.long 0xbf80bf35,0x8000bf35,0x3f803f35,0x80003f35,0xbf35bec4,0xbf80bf6d,0xbf35bf6d,0x8000bec4
.long 0x00000000,0x00000000,0x00000000,0x00000000,0xbf35bec4,0xbf80bf6d,0xbf35bf6d,0x0000bec4
.long 0x3f803f35,0x80003f35,0xbf80bf35,0x0000bf35,0xbf35bf6d,0x3f803ec4,0xbf353ec4,0x0000bf6d
.long 0x80003f80,0x0000bf80,0x80003f80,0x0000bf80,0x3f35bf6d,0xbf803ec4,0x3f353ec4,0x0000bf6d
.long 0xbf803f35,0x80003f35,0x3f80bf35,0x0000bf35,0x3f35bec4,0x3f80bf6d,0x3f35bf6d,0x0000bec4
.long 0x80008000,0x00008000,0x00008000,0x00008000,0xbf353ec4,0xbf803f6d,0xbf353f6d,0x00003ec4
.long 0x3f80bf35,0x8000bf35,0xbf803f35,0x00003f35,0xbf353f6d,0x3f80bec4,0xbf35bec4,0x00003f6d
.long 0x8000bf80,0x80003f80,0x8000bf80,0x00003f80,0x3f353f6d,0xbf80bec4,0x3f35bec4,0x00003f6d
.long 0xbf80bf35,0x8000bf35,0x3f803f35,0x00003f35,0x3f353ec4,0x3f803f6d,0x3f353f6d,0x00003ec4
.long 0x00000000,0x00000000,0x00000000,0x00000000,0x3f353ec4,0x3f803f6d,0x3f353f6d,0x80003ec4
.long 0x3f803f35,0x80003f35,0xbf80bf35,0x0000bf35,0x3f353f6d,0xbf80bec4,0x3f35bec4,0x80003f6d
.long 0x80003f80,0x8000bf80,0x80003f80,0x0000bf80,0xbf353f6d,0x3f80bec4,0xbf35bec4,0x80003f6d
.long 0xbf803f35,0x80003f35,0x3f80bf35,0x8000bf35,0xbf353ec4,0xbf803f6d,0xbf353f6d,0x80003ec4
.long 0x80008000,0x80008000,0x80008000,0x80008000,0x3f35bec4,0x3f80bf6d,0x3f35bf6d,0x8000bec4
.long 0x3f80bf35,0x8000bf35,0xbf803f35,0x80003f35,0x3f35bf6d,0xbf803ec4,0x3f353ec4,0x8000bf6d
.long 0x8000bf80,0x00003f80,0x8000bf80,0x80003f80,0xbf35bf6d,0x3f803ec4,0xbf353ec4,0x8000bf6d
.long 0xbf80bf35,0x8000bf35,0x3f803f35,0x80003f35,0xbf35bec4,0xbf80bf6d,0xbf35bf6d,0x8000bec4
.long 0x00000000,0x00000000,0x00000000,0x00000000,0xbf35bec4,0xbf80bf6d,0xbf35bf6d,0x0000bec4
.long 0x3f803f35,0x80003f35,0xbf80bf35,0x0000bf35,0xbf35bf6d,0x3f803ec4,0xbf353ec4,0x0000bf6d
.long 0x80003f80,0x0000bf80,0x80003f80,0x0000bf80,0x3f35bf6d,0xbf803ec4,0x3f353ec4,0x0000bf6d
.long 0xbf803f35,0x80003f35,0x3f80bf35,0x0000bf35,0x3f35bec4,0x3f80bf6d,0x3f35bf6d,0x0000bec4
.long 0x80008000,0x00008000,0x00008000,0x00008000,0xbf353ec4,0xbf803f6d,0xbf353f6d,0x00003ec4
.long 0x3f80bf35,0x8000bf35,0xbf803f35,0x00003f35,0xbf353f6d,0x3f80bec4,0xbf35bec4,0x00003f6d
.long 0x8000bf80,0x80003f80,0x8000bf80,0x00003f80,0x3f353f6d,0xbf80bec4,0x3f35bec4,0x00003f6d
.long 0xbf80bf35,0x8000bf35,0x3f803f35,0x00003f35,0x3f353ec4,0x3f803f6d,0x3f353f6d,0x00003ec4
.long 0xbf80bf80,0xbf80bf80,0xbf80bf80,0xbf80bf80,0xbf35bf6d,0x0000bec4,0x3f353ec4,0x3f803f6d
.long 0x0000bf35,0x3f803f35,0x80003f35,0xbf80bf35,0x3f35bec4,0x80003f6d,0xbf35bf6d,0x3f803ec4
.long 0x3f808000,0xbf808000,0x3f808000,0xbf808000,0x3f353ec4,0x8000bf6d,0xbf353f6d,0x3f80bec4
.long 0x80003f35,0x3f80bf35,0x8000bf35,0xbf803f35,0xbf353f6d,0x80003ec4,0x3f35bec4,0x3f80bf6d
.long 0xbf803f80,0xbf803f80,0xbf803f80,0xbf803f80,0xbf353f6d,0x80003ec4,0x3f35bec4,0x3f80bf6d
.long 0x00003f35,0x3f80bf35,0x8000bf35,0xbf803f35,0x3f353ec4,0x8000bf6d,0xbf353f6d,0x3f80bec4
.long 0x3f800000,0xbf800000,0x3f808000,0xbf808000,0x3f35bec4,0x00003f6d,0xbf35bf6d,0x3f803ec4
.long 0x8000bf35,0x3f803f35,0x00003f35,0xbf80bf35,0xbf35bf6d,0x0000bec4,0x3f353ec4,0x3f803f6d
.long 0xbf80bf80,0xbf80bf80,0xbf80bf80,0xbf80bf80,0x3f353f6d,0x80003ec4,0xbf35bec4,0xbf80bf6d
.long 0x0000bf35,0x3f803f35,0x80003f35,0xbf80bf35,0xbf353ec4,0x0000bf6d,0x3f353f6d,0xbf80bec4
.long 0x3f800000,0xbf808000,0x3f800000,0xbf808000,0xbf35bec4,0x80003f6d,0x3f35bf6d,0xbf803ec4
.long 0x80003f35,0x3f80bf35,0x0000bf35,0xbf803f35,0x3f35bf6d,0x0000bec4,0xbf353ec4,0xbf803f6d
.long 0xbf803f80,0xbf803f80,0xbf803f80,0xbf803f80,0x3f35bf6d,0x8000bec4,0xbf353ec4,0xbf803f6d
.long 0x80003f35,0x3f80bf35,0x8000bf35,0xbf803f35,0xbf35bec4,0x80003f6d,0x3f35bf6d,0xbf803ec4
.long 0x3f808000,0xbf808000,0x3f808000,0xbf800000,0xbf353ec4,0x8000bf6d,0x3f353f6d,0xbf80bec4
.long 0x8000bf35,0x3f803f35,0x00003f35,0xbf80bf35,0x3f353f6d,0x80003ec4,0xbf35bec4,0xbf80bf6d
.long 0x00000000,0x00000000,0x00000000,0x00000000,0x3e5e3d9c,0x3ec43ea6,0x3ea63ec4,0x3d9c3e5e
.long 0x3f353e96,0x3e963f35,0xbf35be96,0xbe96bf35,0x3f8b3f1e,0xbf6d3e5e,0x3e5ebf6d,0x3f1e3f8b
.long 0x3f803f80,0xbf80bf80,0x3f803f80,0xbf80bf80,0x3ea63fb1,0x3f6dbfd1,0xbfd13f6d,0x3fb13ea6
.long 0xbf353fdb,0x3fdbbf35,0x3f35bfdb,0xbfdb3f35,0xbfd13ff6,0xbec43f8b,0x3f8bbec4,0x3ff6bfd1
.long 0xc0004000,0xc0004000,0xc0004000,0xc0004000,0xbfd13ff6,0xbec43f8b,0x3f8bbec4,0x3ff6bfd1
.long 0xbf353fdb,0x3fdbbf35,0x3f35bfdb,0xbfdb3f35,0x3ea63fb1,0x3f6dbfd1,0xbfd13f6d,0x3fb13ea6
.long 0x3f803f80,0xbf80bf80,0x3f803f80,0xbf80bf80,0x3f8b3f1e,0xbf6d3e5e,0x3e5ebf6d,0x3f1e3f8b
.long 0x3f353e96,0x3e963f35,0xbf35be96,0xbe96bf35,0x3e5e3d9c,0x3ec43ea6,0x3ea63ec4,0x3d9c3e5e
.long 0x00000000,0x00000000,0x00000000,0x00000000,0xbe5ebd9c,0xbec4bea6,0xbea6bec4,0xbd9cbe5e
.long 0x3f353e96,0x3e963f35,0xbf35be96,0xbe96bf35,0xbf8bbf1e,0x3f6dbe5e,0xbe5e3f6d,0xbf1ebf8b
.long 0x3f803f80,0xbf80bf80,0x3f803f80,0xbf80bf80,0xbea6bfb1,0xbf6d3fd1,0x3fd1bf6d,0xbfb1bea6
.long 0xbf353fdb,0x3fdbbf35,0x3f35bfdb,0xbfdb3f35,0x3fd1bff6,0x3ec4bf8b,0xbf8b3ec4,0xbff63fd1
.long 0xc0004000,0xc0004000,0xc0004000,0xc0004000,0x3fd1bff6,0x3ec4bf8b,0xbf8b3ec4,0xbff63fd1
.long 0xbf353fdb,0x3fdbbf35,0x3f35bfdb,0xbfdb3f35,0xbea6bfb1,0xbf6d3fd1,0x3fd1bf6d,0xbfb1bea6
.long 0x3f803f80,0xbf80bf80,0x3f803f80,0xbf80bf80,0xbf8bbf1e,0x3f6dbe5e,0xbe5e3f6d,0xbf1ebf8b
.long 0x3f353e96,0x3e963f35,0xbf35be96,0xbe96bf35,0xbe5ebd9c,0xbec4bea6,0xbea6bec4,0xbd9cbe5e
.long 0x00000000,0x00000000,0x00000000,0x00000000,0xbea6bec4,0xbd9cbe5e,0x3e5e3d9c,0x3ec43ea6
.long 0xbe96bf35,0x3f353e96,0x3e963f35,0xbf35be96,0x3e5ebf6d,0x3f1e3f8b,0xbf8bbf1e,0x3f6dbe5e
.long 0x3f80bf80,0xbf803f80,0x3f80bf80,0xbf803f80,0x3fd1bf6d,0xbfb1bea6,0x3ea63fb1,0x3f6dbfd1
.long 0x3fdbbf35,0x3f35bfdb,0xbfdb3f35,0xbf353fdb,0x3f8bbec4,0x3ff6bfd1,0x3fd1bff6,0x3ec4bf8b
.long 0x00000000,0x00000000,0x00000000,0x00000000,0xbf8b3ec4,0xbff63fd1,0xbfd13ff6,0xbec43f8b
.long 0xbfdb3f35,0xbf353fdb,0x3fdbbf35,0x3f35bfdb,0xbfd13f6d,0x3fb13ea6,0xbea6bfb1,0xbf6d3fd1
.long 0xbf803f80,0x3f80bf80,0xbf803f80,0x3f80bf80,0xbe5e3f6d,0xbf1ebf8b,0x3f8b3f1e,0xbf6d3e5e
.long 0x3e963f35,0xbf35be96,0xbe96bf35,0x3f353e96,0x3ea63ec4,0x3d9c3e5e,0xbe5ebd9c,0xbec4bea6
.long 0x00000000,0x00000000,0x00000000,0x00000000,0x3ea63ec4,0x3d9c3e5e,0xbe5ebd9c,0xbec4bea6
.long 0xbe96bf35,0x3f353e96,0x3e963f35,0xbf35be96,0xbe5e3f6d,0xbf1ebf8b,0x3f8b3f1e,0xbf6d3e5e
.long 0x3f80bf80,0xbf803f80,0x3f80bf80,0xbf803f80,0xbfd13f6d,0x3fb13ea6,0xbea6bfb1,0xbf6d3fd1
.long 0x3fdbbf35,0x3f35bfdb,0xbfdb3f35,0xbf353fdb,0xbf8b3ec4,0xbff63fd1,0xbfd13ff6,0xbec43f8b
.long 0x00000000,0x80000000,0x80000000,0x80000000,0x3f8bbec4,0x3ff6bfd1,0x3fd1bff6,0x3ec4bf8b
.long 0xbfdb3f35,0xbf353fdb,0x3fdbbf35,0x3f35bfdb,0x3fd1bf6d,0xbfb1bea6,0x3ea63fb1,0x3f6dbfd1
.long 0xbf803f80,0x3f80bf80,0xbf803f80,0x3f80bf80,0x3e5ebf6d,0x3f1e3f8b,0xbf8bbf1e,0x3f6dbe5e
.long 0x3e963f35,0xbf35be96,0xbe96bf35,0x3f353e96,0xbea6bec4,0xbd9cbe5e,0x3e5e3d9c,0x3ec43ea6
.long 0x00000000,0x00000000,0x00000000,0x00000000,0xbea6bec4,0xbd9cbe5e,0x3e5e3d9c,0x3ec43ea6
.long 0xbe96bf35,0x3f353e96,0x3e963f35,0xbf35be96,0x3e5ebf6d,0x3f1e3f8b,0xbf8bbf1e,0x3f6dbe5e
.long 0x3f80bf80,0xbf803f80,0x3f80bf80,0xbf803f80,0x3fd1bf6d,0xbfb1bea6,0x3ea63fb1,0x3f6dbfd1
.long 0x3fdbbf35,0x3f35bfdb,0xbfdb3f35,0xbf353fdb,0x3f8bbec4,0x3ff6bfd1,0x3fd1bff6,0x3ec4bf8b
.long 0x00000000,0x00000000,0x00000000,0x00000000,0xbf8b3ec4,0xbff63fd1,0xbfd13ff6,0xbec43f8b
.long 0xbfdb3f35,0xbf353fdb,0x3fdbbf35,0x3f35bfdb,0xbfd13f6d,0x3fb13ea6,0xbea6bfb1,0xbf6d3fd1
.long 0xbf803f80,0x3f80bf80,0xbf803f80,0x3f80bf80,0xbe5e3f6d,0xbf1ebf8b,0x3f8b3f1e,0xbf6d3e5e
.long 0x3e963f35,0xbf35be96,0xbe96bf35,0x3f353e96,0x3ea63ec4,0x3d9c3e5e,0xbe5ebd9c,0xbec4bea6
.long 0x00000000,0x00000000,0x00000000,0x00000000,0x3ea63ec4,0x3d9c3e5e,0xbe5ebd9c,0xbec4bea6
.long 0xbe96bf35,0x3f353e96,0x3e963f35,0xbf35be96,0xbe5e3f6d,0xbf1ebf8b,0x3f8b3f1e,0xbf6d3e5e
.long 0x3f80bf80,0xbf803f80,0x3f80bf80,0xbf803f80,0xbfd13f6d,0x3fb13ea6,0xbea6bfb1,0xbf6d3fd1
.long 0x3fdbbf35,0x3f35bfdb,0xbfdb3f35,0xbf353fdb,0xbf8b3ec4,0xbff63fd1,0xbfd13ff6,0xbec43f8b
.long 0x00000000,0x80000000,0x80000000,0x80000000,0x3f8bbec4,0x3ff6bfd1,0x3fd1bff6,0x3ec4bf8b
.long 0xbfdb3f35,0xbf353fdb,0x3fdbbf35,0x3f35bfdb,0x3fd1bf6d,0xbfb1bea6,0x3ea63fb1,0x3f6dbfd1
.long 0xbf803f80,0x3f80bf80,0xbf803f80,0x3f80bf80,0x3e5ebf6d,0x3f1e3f8b,0xbf8bbf1e,0x3f6dbe5e
.long 0x3e963f35,0xbf35be96,0xbe96bf35,0x3f353e96,0xbea6bec4,0xbd9cbe5e,0x3e5e3d9c,0x3ec43ea6
.long 0x00000000,0x00000000,0x00000000,0x00000000,0xbe5ebd9c,0xbec4bea6,0xbea6bec4,0xbd9cbe5e
.long 0xbf35be96,0xbe96bf35,0x3f353e96,0x3e963f35,0xbf8bbf1e,0x3f6dbe5e,0xbe5e3f6d,0xbf1ebf8b
.long 0xbf80bf80,0x3f803f80,0xbf80bf80,0x3f803f80,0xbea6bfb1,0xbf6d3fd1,0x3fd1bf6d,0xbfb1bea6
.long 0x3f35bfdb,0xbfdb3f35,0xbf353fdb,0x3fdbbf35,0x3fd1bff6,0x3ec4bf8b,0xbf8b3ec4,0xbff63fd1
.long 0x4000c000,0x4000c000,0x4000c000,0x4000c000,0x3fd1bff6,0x3ec4bf8b,0xbf8b3ec4,0xbff63fd1
.long 0x3f35bfdb,0xbfdb3f35,0xbf353fdb,0x3fdbbf35,0xbea6bfb1,0xbf6d3fd1,0x3fd1bf6d,0xbfb1bea6
.long 0xbf80bf80,0x3f803f80,0xbf80bf80,0x3f803f80,0xbf8bbf1e,0x3f6dbe5e,0xbe5e3f6d,0xbf1ebf8b
.long 0xbf35be96,0xbe96bf35,0x3f353e96,0x3e963f35,0xbe5ebd9c,0xbec4bea6,0xbea6bec4,0xbd9cbe5e
.long 0x00000000,0x00000000,0x00000000,0x00000000,0x3e5e3d9c,0x3ec43ea6,0x3ea63ec4,0x3d9c3e5e
.long 0xbf35be96,0xbe96bf35,0x3f353e96,0x3e963f35,0x3f8b3f1e,0xbf6d3e5e,0x3e5ebf6d,0x3f1e3f8b
.long 0xbf80bf80,0x3f803f80,0xbf80bf80,0x3f803f80,0x3ea63fb1,0x3f6dbfd1,0xbfd13f6d,0x3fb13ea6
.long 0x3f35bfdb,0xbfdb3f35,0xbf353fdb,0x3fdbbf35,0xbfd13ff6,0xbec43f8b,0x3f8bbec4,0x3ff6bfd1
.long 0x4000c000,0x4000c000,0x4000c000,0x4000c000,0xbfd13ff6,0xbec43f8b,0x3f8bbec4,0x3ff6bfd1
.long 0x3f35bfdb,0xbfdb3f35,0xbf353fdb,0x3fdbbf35,0x3ea63fb1,0x3f6dbfd1,0xbfd13f6d,0x3fb13ea6
.long 0xbf80bf80,0x3f803f80,0xbf80bf80,0x3f803f80,0x3f8b3f1e,0xbf6d3e5e,0x3e5ebf6d,0x3f1e3f8b
.long 0xbf35be96,0xbe96bf35,0x3f353e96,0x3e963f35,0x3e5e3d9c,0x3ec43ea6,0x3ea63ec4,0x3d9c3e5e
.long 0x3f800000,0x3f800000,0x3f800000,0x3f800000,0x3f800000,0x3f7ffb11,0x3f7fec43,0x3f7fd397
.long 0x3f800000,0x3f7fec43,0x3f7fb10f,0x3f7f4e6d,0x3f800000,0x3f7fd397,0x3f7f4e6d,0x3f7e70b0
.long 0x3f800000,0x3f7fb10f,0x3f7ec46d,0x3f7d3aac,0x3f800000,0x3f7f84ab,0x3f7e1324,0x3f7baccd
.long 0x3f800000,0x3f7f4e6d,0x3f7d3aac,0x3f79c79d,0x3f800000,0x3f7f0e58,0x3f7c3b28,0x3f778bc5
.long 0x3f800000,0x3f7ec46d,0x3f7b14be,0x3f74fa0b,0x3f800000,0x3f7e70b0,0x3f79c79d,0x3f721352
.long 0x3f800000,0x3f7e1324,0x3f7853f8,0x3f6ed89e,0x3f800000,0x3f7dabcc,0x3f76ba07,0x3f6b4b0c
.long 0x3f800000,0x3f7d3aac,0x3f74fa0b,0x3f676bd8,0x3f800000,0x3f7cbfc9,0x3f731447,0x3f633c5a
.long 0x3f800000,0x3f7c3b28,0x3f710908,0x3f5ebe05,0x3f800000,0x3f7baccd,0x3f6ed89e,0x3f59f26a
.long 0x3f800000,0x3f800000,0x3f800000,0x3f800000,0x3f7fb10f,0x3f7f84ab,0x3f7f4e6d,0x3f7f0e58
.long 0x3f7ec46d,0x3f7e1324,0x3f7d3aac,0x3f7c3b28,0x3f7d3aac,0x3f7baccd,0x3f79c79d,0x3f778bc5
.long 0x3f7b14be,0x3f7853f8,0x3f74fa0b,0x3f710908,0x3f7853f8,0x3f740bdd,0x3f6ed89e,0x3f68bf3c
.long 0x3f74fa0b,0x3f6ed89e,0x3f676bd8,0x3f5ebe05,0x3f710908,0x3f68bf3c,0x3f5ebe05,0x3f531849
.long 0x3f6c835e,0x3f61c598,0x3f54db31,0x3f45e403,0x3f676bd8,0x3f59f26a,0x3f49d112,0x3f373a23
.long 0x3f61c598,0x3f514d3d,0x3f3daef9,0x3f273656,0x3f5b941a,0x3f47de65,0x3f3085bb,0x3f15f6d9
.long 0x3f54db31,0x3f3daef9,0x3f226799,0x3f039c3d,0x3f4d9f02,0x3f32c8c9,0x3f13682a,0x3ee0924f
.long 0x3f45e403,0x3f273656,0x3f039c3d,0x3eb8442a,0x3f3daef9,0x3f1b02c6,0x3ee63375,0x3e8e9a22
.long 0x3f800000,0x3f800000,0x3f800000,0x3f800000,0x3f7ec46d,0x3f7e70b0,0x3f7e1324,0x3f7dabcc
.long 0x3f7b14be,0x3f79c79d,0x3f7853f8,0x3f76ba07,0x3f74fa0b,0x3f721352,0x3f6ed89e,0x3f6b4b0c
.long 0x3f6c835e,0x3f676bd8,0x3f61c598,0x3f5b941a,0x3f61c598,0x3f59f26a,0x3f514d3d,0x3f47de65
.long 0x3f54db31,0x3f49d112,0x3f3daef9,0x3f3085bb,0x3f45e403,0x3f373a23,0x3f273656,0x3f15f6d9
.long 0x3f3504f3,0x3f226799,0x3f0e39da,0x3ef15aea,0x3f226799,0x3f0b9a6b,0x3ee63375,0x3eb263ef
.long 0x3f0e39da,0x3ee63375,0x3eac7cd4,0x3e605c13,0x3ef15aea,0x3eb263ef,0x3e605c13,0x3dafb680
.long 0x3ec3ef15,0x3e78cfcc,0x3dc8bd36,0xbd48fb30,0x3e94a031,0x3e09cf86,0xbcc90ab0,0xbe3b6ecf
.long 0x3e47c5c2,0x3cc90ab0,0xbe164083,0xbea09ae5,0x3dc8bd36,0xbdafb680,0xbe888e93,0xbee0924f
.long 0x3f800000,0x3f800000,0x3f800000,0x3f800000,0x3f7d3aac,0x3f7cbfc9,0x3f7c3b28,0x3f7baccd
.long 0x3f74fa0b,0x3f731447,0x3f710908,0x3f6ed89e,0x3f676bd8,0x3f633c5a,0x3f5ebe05,0x3f59f26a
.long 0x3f54db31,0x3f4d9f02,0x3f45e403,0x3f3daef9,0x3f3daef9,0x3f32c8c9,0x3f273656,0x3f1b02c6
.long 0x3f226799,0x3f13682a,0x3f039c3d,0x3ee63375,0x3f039c3d,0x3ee0924f,0x3eb8442a,0x3e8e9a22
.long 0x3ec3ef15,0x3e94a031,0x3e47c5c2,0x3dc8bd36,0x3e78cfcc,0x3e09cf86,0x3cc90ab0,0xbdafb680
.long 0x3dc8bd36,0xbcc90ab0,0xbe164083,0xbe888e93,0xbd48fb30,0xbe3b6ecf,0xbea09ae5,0xbee0924f
.long 0xbe47c5c2,0xbeac7cd4,0xbef15aea,0xbf187fc0,0xbeac7cd4,0xbef6e0cb,0xbf1d7fd1,0xbf3b8f3b
.long 0xbef15aea,0xbf1d7fd1,0xbf3daef9,0xbf584853,0xbf187fc0,0xbf3b8f3b,0xbf584853,0xbf6db293
.long 0x3f800000,0x3f800000,0x3f800000,0x3f800000,0x3f7b14be,0x3f7a7302,0x3f79c79d,0x3f791298
.long 0x3f6c835e,0x3f6a09a7,0x3f676bd8,0x3f64aa59,0x3f54db31,0x3f4f7a1f,0x3f49d112,0x3f43e200
.long 0x3f3504f3,0x3f2beb4a,0x3f226799,0x3f187fc0,0x3f0e39da,0x3f00e7e4,0x3ee63375,0x3ec9b953
.long 0x3ec3ef15,0x3ea09ae5,0x3e78cfcc,0x3e2f10a2,0x3e47c5c2,0x3de1bc2e,0x3cc90ab0,0xbd7b2b74
.long 0x00000000,0xbdc8bd36,0xbe47c5c2,0xbe94a031,0xbe47c5c2,0xbe9aa086,0xbecf7bca,0xbf00e7e4
.long 0xbec3ef15,0xbefc5d27,0xbf187fc0,0xbf3085bb,0xbf0e39da,0xbf299415,0xbf41d870,0xbf5695e5
.long 0xbf3504f3,0xbf4d9f02,0xbf61c598,0xbf710908,0xbf54db31,0xbf68bf3c,0xbf76ba07,0xbf7e70b0
.long 0xbf6c835e,0xbf79c79d,0xbf7fb10f,0xbf7e1324,0xbf7b14be,0xbf7ffb11,0xbf7c3b28,0xbf6ff573
.long 0x3f800000,0x3f800000,0x3f800000,0x3f800000,0x3f7853f8,0x3f778bc5,0x3f76ba07,0x3f75dec6
.long 0x3f61c598,0x3f5ebe05,0x3f5b941a,0x3f584853,0x3f3daef9,0x3f373a23,0x3f3085bb,0x3f299415
.long 0x3f0e39da,0x3f039c3d,0x3ef15aea,0x3edae880,0x3eac7cd4,0x3e8e9a22,0x3e605c13,0x3e22abb6
.long 0x3dc8bd36,0x3cc90ab0,0xbd48fb30,0xbdfab273,0xbe164083,0xbe6c9a7f,0xbea09ae5,0xbec9b953
.long 0xbec3ef15,0xbef15aea,0xbf0e39da,0xbf226799,0xbf187fc0,0xbf2e3bde,0xbf41d870,0xbf531849
.long 0xbf45e403,0xbf584853,0xbf676bd8,0xbf731447,0xbf676bd8,0xbf740bdd,0xbf7c3b28,0xbf7fd397
.long 0xbf7b14be,0xbf7fb10f,0xbf7ec46d,0xbf7853f8,0xbf7fb10f,0xbf7a7302,0xbf6ed89e,0xbf5d2d53
.long 0xbf74fa0b,0xbf64aa59,0xbf4d9f02,0xbf3085bb,0xbf5b941a,0xbf3fc767,0xbf1d7fd1,0xbeebcbbb
.long 0x3f800000,0x3f800000,0x3f800000,0x3f800000,0x3f74fa0b,0x3f740bdd,0x3f731447,0x3f721352
.long 0x3f54db31,0x3f514d3d,0x3f4d9f02,0x3f49d112,0x3f226799,0x3f1b02c6,0x3f13682a,0x3f0b9a6b
.long 0x3ec3ef15,0x3eac7cd4,0x3e94a031,0x3e78cfcc,0x3dc8bd36,0x3d16c32c,0xbcc90ab0,0xbdafb680
.long 0xbe47c5c2,0xbe888e93,0xbeac7cd4,0xbecf7bca,0xbef15aea,0xbf0b9a6b,0xbf1d7fd1,0xbf2e3bde
.long 0xbf3504f3,0xbf45e403,0xbf54db31,0xbf61c598,0xbf61c598,0xbf6db293,0xbf76ba07,0xbf7cbfc9
.long 0xbf7b14be,0xbf7f4e6d,0xbf7fb10f,0xbf7c3b28,0xbf7ec46d,0xbf791298,0xbf6ed89e,0xbf604621
.long 0xbf6c835e,0xbf5b941a,0xbf45e403,0xbf2beb4a,0xbf45e403,0xbf299415,0xbf08f59b,0xbec9b953
.long 0xbf0e39da,0xbecf7bca,0xbe78cfcc,0xbd96a905,0xbe94a031,0xbde1bc2e,0x3d96a905,0x3e827dc0
.long 0x3f800000,0x3f800000,0x3f800000,0x3f800000,0x3f710908,0x3f6ff573,0x3f6ed89e,0x3f6db293
.long 0x3f45e403,0x3f41d870,0x3f3daef9,0x3f396842,0x3f039c3d,0x3ef6e0cb,0x3ee63375,0x3ed53641
.long 0x3e47c5c2,0x3e164083,0x3dc8bd36,0x3d48fb30,0xbe164083,0xbe541501,0xbe888e93,0xbea68f12
.long 0xbef15aea,0xbf08f59b,0xbf187fc0,0xbf273656,0xbf3daef9,0xbf4bbbf8,0xbf584853,0xbf633c5a
.long 0xbf6c835e,0xbf74fa0b,0xbf7b14be,0xbf7ec46d,0xbf7fb10f,0xbf7f84ab,0xbf7c3b28,0xbf75dec6
.long 0xbf74fa0b,0xbf6a09a7,0xbf5b941a,0xbf49d112,0xbf4d9f02,0xbf373a23,0xbf1d7fd1,0xbf00e7e4
.long 0xbf0e39da,0xbedae880,0xbe94a031,0xbe164083,0xbe78cfcc,0xbdafb680,0x3d96a905,0x3e6c9a7f
.long 0x3dc8bd36,0x3e888e93,0x3edae880,0x3f13682a,0x3edae880,0x3f15f6d9,0x3f396842,0x3f5695e5
.long 0x80000000,0x80000000,0x80000000,0x80000000,0x80000000,0xbc490e90,0xbcc90ab0,0xbd16c32c
.long 0x80000000,0xbcc90ab0,0xbd48fb30,0xbd96a905,0x80000000,0xbd16c32c,0xbd96a905,0xbde1bc2e
.long 0x80000000,0xbd48fb30,0xbdc8bd36,0xbe164083,0x80000000,0xbd7b2b74,0xbdfab273,0xbe3b6ecf
.long 0x80000000,0xbd96a905,0xbe164083,0xbe605c13,0x80000000,0xbdafb680,0xbe2f10a2,0xbe827dc0
.long 0x80000000,0xbdc8bd36,0xbe47c5c2,0xbe94a031,0x80000000,0xbde1bc2e,0xbe605c13,0xbea68f12
.long 0x80000000,0xbdfab273,0xbe78cfcc,0xbeb8442a,0x80000000,0xbe09cf86,0xbe888e93,0xbec9b953
.long 0x80000000,0xbe164083,0xbe94a031,0xbedae880,0x80000000,0xbe22abb6,0xbea09ae5,0xbeebcbbb
.long 0x80000000,0xbe2f10a2,0xbeac7cd4,0xbefc5d27,0x80000000,0xbe3b6ecf,0xbeb8442a,0xbf064b82
.long 0x80000000,0x80000000,0x80000000,0x80000000,0xbd48fb30,0xbd7b2b74,0xbd96a905,0xbdafb680
.long 0xbdc8bd36,0xbdfab273,0xbe164083,0xbe2f10a2,0xbe164083,0xbe3b6ecf,0xbe605c13,0xbe827dc0
.long 0xbe47c5c2,0xbe78cfcc,0xbe94a031,0xbeac7cd4,0xbe78cfcc,0xbe9aa086,0xbeb8442a,0xbed53641
.long 0xbe94a031,0xbeb8442a,0xbedae880,0xbefc5d27,0xbeac7cd4,0xbed53641,0xbefc5d27,0xbf10d3cd
.long 0xbec3ef15,0xbef15aea,0xbf0e39da,0xbf226799,0xbedae880,0xbf064b82,0xbf1d7fd1,0xbf32c8c9
.long 0xbef15aea,0xbf13682a,0xbf2beb4a,0xbf41d870,0xbf039c3d,0xbf1ff6cb,0xbf396842,0xbf4f7a1f
.long 0xbf0e39da,0xbf2beb4a,0xbf45e403,0xbf5b941a,0xbf187fc0,0xbf373a23,0xbf514d3d,0xbf660f88
.long 0xbf226799,0xbf41d870,0xbf5b941a,0xbf6ed89e,0xbf2beb4a,0xbf4bbbf8,0xbf64aa59,0xbf75dec6
.long 0x80000000,0x80000000,0x80000000,0x80000000,0xbdc8bd36,0xbde1bc2e,0xbdfab273,0xbe09cf86
.long 0xbe47c5c2,0xbe605c13,0xbe78cfcc,0xbe888e93,0xbe94a031,0xbea68f12,0xbeb8442a,0xbec9b953
.long 0xbec3ef15,0xbedae880,0xbef15aea,0xbf039c3d,0xbef15aea,0xbf064b82,0xbf13682a,0xbf1ff6cb
.long 0xbf0e39da,0xbf1d7fd1,0xbf2beb4a,0xbf396842,0xbf226799,0xbf32c8c9,0xbf41d870,0xbf4f7a1f
.long 0xbf3504f3,0xbf45e403,0xbf54db31,0xbf61c598,0xbf45e403,0xbf5695e5,0xbf64aa59,0xbf6ff573
.long 0xbf54db31,0xbf64aa59,0xbf710908,0xbf79c79d,0xbf61c598,0xbf6ff573,0xbf79c79d,0xbf7f0e58
.long 0xbf6c835e,0xbf7853f8,0xbf7ec46d,0xbf7fb10f,0xbf74fa0b,0xbf7dabcc,0xbf7fec43,0xbf7baccd
.long 0xbf7b14be,0xbf7fec43,0xbf7d3aac,0xbf731447,0xbf7ec46d,0xbf7f0e58,0xbf76ba07,0xbf660f88
.long 0x80000000,0x80000000,0x80000000,0x80000000,0xbe164083,0xbe22abb6,0xbe2f10a2,0xbe3b6ecf
.long 0xbe94a031,0xbea09ae5,0xbeac7cd4,0xbeb8442a,0xbedae880,0xbeebcbbb,0xbefc5d27,0xbf064b82
.long 0xbf0e39da,0xbf187fc0,0xbf226799,0xbf2beb4a,0xbf2beb4a,0xbf373a23,0xbf41d870,0xbf4bbbf8
.long 0xbf45e403,0xbf514d3d,0xbf5b941a,0xbf64aa59,0xbf5b941a,0xbf660f88,0xbf6ed89e,0xbf75dec6
.long 0xbf6c835e,0xbf74fa0b,0xbf7b14be,0xbf7ec46d,0xbf7853f8,0xbf7dabcc,0xbf7fec43,0xbf7f0e58
.long 0xbf7ec46d,0xbf7fec43,0xbf7d3aac,0xbf76ba07,0xbf7fb10f,0xbf7baccd,0xbf731447,0xbf660f88
.long 0xbf7b14be,0xbf710908,0xbf61c598,0xbf4d9f02,0xbf710908,0xbf604621,0xbf49d112,0xbf2e3bde
.long 0xbf61c598,0xbf49d112,0xbf2beb4a,0xbf08f59b,0xbf4d9f02,0xbf2e3bde,0xbf08f59b,0xbebe1d4a
.long 0x80000000,0x80000000,0x80000000,0x80000000,0xbe47c5c2,0xbe541501,0xbe605c13,0xbe6c9a7f
.long 0xbec3ef15,0xbecf7bca,0xbedae880,0xbee63375,0xbf0e39da,0xbf15f6d9,0xbf1d7fd1,0xbf24d225
.long 0xbf3504f3,0xbf3daef9,0xbf45e403,0xbf4d9f02,0xbf54db31,0xbf5d2d53,0xbf64aa59,0xbf6b4b0c
.long 0xbf6c835e,0xbf731447,0xbf7853f8,0xbf7c3b28,0xbf7b14be,0xbf7e70b0,0xbf7fec43,0xbf7f84ab
.long 0xbf800000,0xbf7ec46d,0xbf7b14be,0xbf74fa0b,0xbf7b14be,0xbf740bdd,0xbf6a09a7,0xbf5d2d53
.long 0xbf6c835e,0xbf5ebe05,0xbf4d9f02,0xbf396842,0xbf54db31,0xbf3fc767,0xbf273656,0xbf0b9a6b
.long 0xbf3504f3,0xbf187fc0,0xbef15aea,0xbeac7cd4,0xbf0e39da,0xbed53641,0xbe888e93,0xbde1bc2e
.long 0xbec3ef15,0xbe605c13,0xbd48fb30,0x3dfab273,0xbe47c5c2,0xbc490e90,0x3e2f10a2,0x3eb263ef
.long 0x80000000,0x80000000,0x80000000,0x80000000,0xbe78cfcc,0xbe827dc0,0xbe888e93,0xbe8e9a22
.long 0xbef15aea,0xbefc5d27,0xbf039c3d,0xbf08f59b,0xbf2beb4a,0xbf32c8c9,0xbf396842,0xbf3fc767
.long 0xbf54db31,0xbf5b941a,0xbf61c598,0xbf676bd8,0xbf710908,0xbf75dec6,0xbf79c79d,0xbf7cbfc9
.long 0xbf7ec46d,0xbf7fec43,0xbf7fb10f,0xbf7e1324,0xbf7d3aac,0xbf791298,0xbf731447,0xbf6b4b0c
.long 0xbf6c835e,0xbf61c598,0xbf54db31,0xbf45e403,0xbf4d9f02,0xbf3b8f3b,0xbf273656,0xbf10d3cd
.long 0xbf226799,0xbf08f59b,0xbedae880,0xbea09ae5,0xbedae880,0xbe9aa086,0xbe2f10a2,0xbd16c32c
.long 0xbe47c5c2,0xbd48fb30,0x3dc8bd36,0x3e78cfcc,0x3d48fb30,0x3e541501,0x3eb8442a,0x3f00e7e4
.long 0x3e94a031,0x3ee63375,0x3f187fc0,0x3f396842,0x3f039c3d,0x3f299415,0x3f49d112,0x3f633c5a
.long 0x80000000,0x80000000,0x80000000,0x80000000,0xbe94a031,0xbe9aa086,0xbea09ae5,0xbea68f12
.long 0xbf0e39da,0xbf13682a,0xbf187fc0,0xbf1d7fd1,0xbf45e403,0xbf4bbbf8,0xbf514d3d,0xbf5695e5
.long 0xbf6c835e,0xbf710908,0xbf74fa0b,0xbf7853f8,0xbf7ec46d,0xbf7fd397,0xbf7fec43,0xbf7f0e58
.long 0xbf7b14be,0xbf76ba07,0xbf710908,0xbf6a09a7,0xbf61c598,0xbf5695e5,0xbf49d112,0xbf3b8f3b
.long 0xbf3504f3,0xbf226799,0xbf0e39da,0xbef15aea,0xbef15aea,0xbebe1d4a,0xbe888e93,0xbe22abb6
.long 0xbe47c5c2,0xbd96a905,0x3d48fb30,0x3e2f10a2,0x3dc8bd36,0x3e6c9a7f,0x3eb8442a,0x3ef6e0cb
.long 0x3ec3ef15,0x3f039c3d,0x3f226799,0x3f3daef9,0x3f226799,0x3f3fc767,0x3f584853,0x3f6b4b0c
.long 0x3f54db31,0x3f6a09a7,0x3f7853f8,0x3f7f4e6d,0x3f74fa0b,0x3f7e70b0,0x3f7f4e6d,0x3f778bc5
.long 0x80000000,0x80000000,0x80000000,0x80000000,0xbeac7cd4,0xbeb263ef,0xbeb8442a,0xbebe1d4a
.long 0xbf226799,0xbf273656,0xbf2beb4a,0xbf3085bb,0xbf5b941a,0xbf604621,0xbf64aa59,0xbf68bf3c
.long 0xbf7b14be,0xbf7d3aac,0xbf7ec46d,0xbf7fb10f,0xbf7d3aac,0xbf7a7302,0xbf76ba07,0xbf721352
.long 0xbf61c598,0xbf584853,0xbf4d9f02,0xbf41d870,0xbf2beb4a,0xbf1b02c6,0xbf08f59b,0xbeebcbbb
.long 0xbec3ef15,0xbe94a031,0xbe47c5c2,0xbdc8bd36,0xbd48fb30,0x3d7b2b74,0x3e2f10a2,0x3e8e9a22
.long 0x3e94a031,0x3ecf7bca,0x3f039c3d,0x3f1d7fd1,0x3f187fc0,0x3f32c8c9,0x3f49d112,0x3f5d2d53
.long 0x3f54db31,0x3f676bd8,0x3f74fa0b,0x3f7d3aac,0x3f7853f8,0x3f7f0e58,0x3f7f4e6d,0x3f791298
.long 0x3f7ec46d,0x3f76ba07,0x3f676bd8,0x3f514d3d,0x3f676bd8,0x3f4f7a1f,0x3f3085bb,0x3f0b9a6b
.size L_table, 12288
.section .rodata,"a"
.p2align 6
.amdhsa_kernel gated_mix__spectral_fnet__sliding_local_dilated__prompt_kernel
  .amdhsa_next_free_vgpr 256
  .amdhsa_next_free_sgpr 100
  .amdhsa_accum_offset 256
  .amdhsa_group_segment_fixed_size 0
  .amdhsa_kernarg_size 96
  .amdhsa_user_sgpr_count 2
  .amdhsa_user_sgpr_kernarg_segment_ptr 1
  .amdhsa_system_sgpr_workgroup_id_x 1
.end_amdhsa_kernel
```
